```python
import torch

def _softmax(x, axis=-1):
    return torch.softmax(x, dim=axis)
def _gelu(x):
    return torch.nn.functional.gelu(x, approximate="tanh")
def _silu(x):
    return torch.nn.functional.silu(x)
def _sigmoid(x):
    return torch.sigmoid(x)
def _layernorm(x, axis=-1, eps=1e-5):
    m = x.mean(dim=axis, keepdim=True)
    v = x.var(dim=axis, keepdim=True, unbiased=False)
    return (x - m) / torch.sqrt(v + eps)
def _scatter_add(tgt, idx, src, axis=0):
    return tgt.clone().index_add_(axis, idx, src)
def _segment_sum(src, seg, n):
    out = torch.zeros((n,) + src.shape[1:], dtype=src.dtype)
    return out.index_add_(0, seg, src)
def _pad(x, pw):
    flat = tuple(v for pair in reversed(pw) for v in pair)
    return torch.nn.functional.pad(x, flat)

kernel_name = 'parallel_sum__gqa_block_cached__mixer_channel_mlp__decode'

def setup_inputs():

    _w = (lambda a: (lambda t: t.to(torch.bfloat16) if t.is_floating_point() else t)(torch.as_tensor(a)))
    def _A_setup():
        B, Sq, D = 4, 1, 1024
        Hq, Hkv, Sk, Dh = 32, 4, 16384, 128
        assert Hq % Hkv == 0, (Hq, Hkv)
        return {
            "x": _w((lambda *s: torch.randn(*s, dtype=torch.bfloat16) * 0.05)(B, Sq, D)),
            "k_cache": _w((lambda *s: torch.randn(*s, dtype=torch.bfloat16) * 3.2)(B, Hkv, Sk, Dh)),
            "v_cache": _w((lambda *s: torch.randn(*s, dtype=torch.bfloat16) * 0.4)(B, Hkv, Sk, Dh)),
            "wq": _w((lambda *s: torch.randn(*s, dtype=torch.bfloat16) * 3.2)(D, Hq * Dh) * (D ** -0.5)),
            "wo": _w((lambda *s: torch.randn(*s, dtype=torch.bfloat16) * 0.4)(Hq * Dh, D) * ((Hq * Dh) ** -0.5)),
        }
    _A_in = _A_setup()

    def _B_setup():
        B, S, D, F = 4, 1, 1024, 3584
        return {
            "x": _w((lambda *s: torch.randn(*s, dtype=torch.bfloat16) * 0.05)(B, S, D)),
            "w1": _w((lambda *s: torch.randn(*s, dtype=torch.bfloat16) * 3.2)(D, F) * (D ** -0.5)),
            "b1": _w((lambda *s: torch.randn(*s, dtype=torch.bfloat16) * 1.6)(F)),
            "w2": _w((lambda *s: torch.randn(*s, dtype=torch.bfloat16) * 0.1)(F, D) * (F ** -0.5)),
            "b2": _w((lambda *s: torch.randn(*s, dtype=torch.bfloat16) * 0.1)(D)),
        }
    _B_in = _B_setup()

    return {
        "A_x": _A_in["x"],
        "A_k_cache": _A_in["k_cache"],
        "A_v_cache": _A_in["v_cache"],
        "A_wq": _A_in["wq"],
        "A_wo": _A_in["wo"],
        "B_x": _B_in["x"],
        "B_w1": _B_in["w1"],
        "B_b1": _B_in["b1"],
        "B_w2": _B_in["w2"],
        "B_b2": _B_in["b2"],
    }

def reference(A_x, A_k_cache, A_v_cache, A_wq, A_wo, B_x, B_w1, B_b1, B_w2, B_b2):
    def _A_ref(x, k_cache, v_cache, wq, wo):
        B, Sq, D = x.shape
        Hq, Dh = 32, 128
        Hkv = k_cache.shape[1]
        rep = Hq // Hkv
        q = (lambda x, *d: x.permute(*d))((x @ wq).reshape(B, Sq, Hq, Dh), 0, 2, 1, 3)
        k = (lambda x, n, axis: torch.repeat_interleave(x, n, dim=axis))(k_cache, rep, axis=1)
        v = (lambda x, n, axis: torch.repeat_interleave(x, n, dim=axis))(v_cache, rep, axis=1)
        scores = torch.einsum("bhqd,bhkd->bhqk", q, k) * (Dh ** -0.5)
        p = _softmax(scores, axis=-1)
        o = torch.einsum("bhqk,bhkd->bhqd", p, v)
        return (lambda x, *d: x.permute(*d))(o, 0, 2, 1, 3).reshape(B, Sq, Hq * Dh) @ wo

    def _B_ref(x, w1, b1, w2, b2):
        y = _layernorm(x, axis=-1)
        h = _gelu(torch.einsum("bsd,df->bsf", y, w1) + b1)
        return torch.einsum("bsf,fd->bsd", h, w2) + b2

    x = A_x
    xn = _layernorm(x, axis=-1)
    return x + _A_ref(xn, A_k_cache, A_v_cache, A_wq, A_wo) + _B_ref(xn, B_w1, B_b1, B_w2, B_b2)
```

```asm
; @launch grid=(256,1,1) block=(256,1,1) lds=152064
.amdgcn_target "amdgcn-amd-amdhsa--gfx950"
.text
.globl parallel_sum__gqa_block_cached__mixer_channel_mlp__decode_kernel
.p2align 8
.type parallel_sum__gqa_block_cached__mixer_channel_mlp__decode_kernel,@function
parallel_sum__gqa_block_cached__mixer_channel_mlp__decode_kernel:
    s_cmp_ge_u32 s2, 256
    s_cbranch_scc1 L_end
    s_load_dwordx16 s[16:31], s[0:1], 0
    s_load_dwordx8 s[32:39], s[0:1], 64
    s_load_dwordx2 s[40:41], s[0:1], 96
    s_getpc_b64 s[42:43]
L_pc:
    v_lshlrev_b32 v58, 7, v0
    v_min_u32 v58, L_end-L_pc, v58
    global_load_dword v58, v58, s[42:43]
    v_lshrrev_b32 v13, 6, v0
    v_and_b32 v1, 63, v0
    v_readfirstlane_b32 s3, v13
    v_lshlrev_b32 v4, 4, v1
    v_lshl_add_u32 v3, v13, 11, v4
    s_bfe_u32 s77, s2, 0x20001
    s_and_b32 s78, s2, 1
    s_lshl_b32 s78, s78, 5
    s_lshr_b32 s72, s2, 3
    s_add_u32 s78, s78, s72
    v_lshrrev_b32 v14, 3, v0
    v_and_b32 v15, 7, v14
    v_lshl_add_u32 v14, v13, 6, v15
    s_lshl_b32 s72, s77, 8
    v_add_u32 v14, s72, v14
    v_and_b32 v15, 0x70, v4
    v_lshl_add_u32 v56, v14, 13, v15
    v_mov_b32 v59, 0
    s_lshl_b32 s85, s78, 7
    s_lshl_b32 s89, s3, 13
    s_mov_b32 s54, 0x800000
    s_mov_b32 s55, 0x20000
    s_mov_b32 s59, 0x20000
    s_waitcnt lgkmcnt(0)
    global_load_dwordx4 v[64:67], v3, s[16:17]
    global_load_dwordx4 v[68:71], v3, s[16:17] offset:1024
    s_mov_b64 s[52:53], s[22:23]
    s_mov_b64 s[56:57], s[28:29]
    s_add_u32 m0, s89, 0
    s_add_u32 s27, s85, 0
    buffer_load_dwordx4 v56, s[52:55], s27 offen nt lds
    s_add_u32 m0, s89, 1024
    s_add_u32 s27, s85, 65536
    buffer_load_dwordx4 v56, s[52:55], s27 offen nt lds
    s_add_u32 m0, s89, 2048
    s_add_u32 s27, s85, 131072
    buffer_load_dwordx4 v56, s[52:55], s27 offen nt lds
    s_add_u32 m0, s89, 3072
    s_add_u32 s27, s85, 196608
    buffer_load_dwordx4 v56, s[52:55], s27 offen nt lds
    s_add_u32 m0, s89, 4096
    s_add_u32 s27, s85, 262144
    buffer_load_dwordx4 v56, s[52:55], s27 offen nt lds
    s_add_u32 m0, s89, 5120
    s_add_u32 s27, s85, 327680
    buffer_load_dwordx4 v56, s[52:55], s27 offen nt lds
    s_add_u32 m0, s89, 6144
    s_add_u32 s27, s85, 393216
    buffer_load_dwordx4 v56, s[52:55], s27 offen nt lds
    s_add_u32 m0, s89, 7168
    s_add_u32 s27, s85, 458752
    buffer_load_dwordx4 v56, s[52:55], s27 offen nt lds
    s_lshr_b32 s73, s2, 3
    s_lshr_b32 s72, s2, 6
    s_sub_u32 s0, s73, s72
    s_and_b32 s72, s73, 7
    s_cmp_gt_u32 s72, 3
    s_subb_u32 s0, s0, 0
    s_mul_i32 s43, s0, 37
    s_lshr_b32 s43, s43, 8
    s_and_b32 s73, s2, 7
    s_sub_u32 s73, s73, s43
    s_mul_i32 s73, s73, 7
    s_add_u32 s0, s0, s73
    s_cmp_lg_u32 s72, 3
    s_cselect_b32 s58, 0x700000, 0
    s_cselect_b32 s0, s0, 60
    s_sub_u32 s73, s43, s77
    s_lshl_b32 s73, s73, 8
    v_add_u32 v14, s73, v14
    v_mul_u32_u24 v57, 7168, v14
    v_add_u32 v57, v57, v15
    s_lshl_b32 s1, s0, 7
    global_load_dword v5, v59, s[40:41] sc1
    v_bfe_u32 v14, v1, 2, 2
    v_bfe_u32 v15, v1, 1, 1
    v_lshl_add_u32 v14, v15, 2, v14
    v_lshlrev_b32 v2, 8, v14
    v_lshl_add_u32 v2, v13, 12, v2
    v_lshrrev_b32 v14, 4, v1
    v_lshl_add_u32 v2, v14, 5, v2
    v_and_b32 v15, 1, v1
    v_lshl_add_u32 v2, v15, 4, v2
    s_and_b32 s72, s2, 7
    s_lshl_b32 s72, s72, 1
    s_bfe_u32 s73, s2, 0x10003
    s_add_u32 s72, s72, s73
    s_lshr_b32 s74, s72, 2
    s_and_b32 s75, s72, 3
    s_lshr_b32 s76, s2, 4
    s_mul_i32 s38, s72, 5
    s_lshl_b32 s72, s72, 22
    s_lshl_b32 s73, s76, 14
    s_add_u32 s72, s72, s73
    s_add_u32 s44, s18, s72
    s_addc_u32 s45, s19, 0
    s_add_u32 s48, s20, s72
    s_addc_u32 s49, s21, 0
    s_lshr_b32 s79, s2, 3
    s_getreg_b32 s80, hwreg(HW_REG_XCC_ID, 0, 4)
    s_mov_b32 s47, 0x20000
    s_mov_b32 s51, 0x20000
    s_mov_b32 s63, 0x20000
    s_mov_b32 s67, 0x20000
    s_mov_b32 s71, 0x20000
    s_sub_u32 s46, 0x400000, s73
    s_mov_b32 s50, s46
    s_mov_b32 s62, 0x800000
    s_mov_b32 s66, 0x700000
    s_mov_b32 s70, 6291456
    s_mov_b64 s[60:61], s[24:25]
    s_mov_b64 s[64:65], s[32:33]
    s_mov_b64 s[68:69], s[40:41]
    s_mov_b32 s81, 0x05040100
    s_mov_b32 s82, 0x07060302
    s_mov_b32 s83, 0x3db504f3
    s_mov_b32 s84, 0x3fb8aa3b
    v_lshrrev_b32 v13, 4, v1
    v_lshlrev_b32 v10, 4, v13
    v_bfe_u32 v14, v1, 2, 2
    v_lshl_add_u32 v14, v13, 3, v14
    v_and_b32 v15, 3, v1
    v_lshlrev_b32 v15, 3, v15
    v_lshl_add_u32 v6, v14, 7, v15
    v_and_b32 v14, 15, v1
    v_lshlrev_b32 v14, 2, v14
    v_lshl_add_u32 v7, v13, 16, v14
    v_and_b32 v14, 0xf0, v4
    v_lshlrev_b32 v15, 5, v13
    v_xor_b32 v14, v14, v15
    v_lshl_add_u32 v9, v13, 11, v14
    s_and_b32 s87, s2, 7
    s_lshl_b32 s87, s87, 8
    v_mov_b32 v24, 0
    v_mov_b32 v25, 0
    v_mov_b32 v26, 0
    v_mov_b32 v27, 0
    v_add_u32 v13, s89, v4
    v_add_u32 v13, 105472, v13
    ds_write_b128 v13, v[24:27]
    s_waitcnt vmcnt(9)
    v_lshlrev_b32 v80, 16, v64
    s_add_u32 s26, s38, 0
    s_and_b32 s26, s26, 15
    s_lshl_b32 s26, s26, 18
    buffer_load_dwordx4 a[0:3], v2, s[44:47], s26 offen offset:0 nt
    v_and_b32 v81, 0xffff0000, v64
    v_lshlrev_b32 v82, 16, v65
    v_and_b32 v83, 0xffff0000, v65
    v_lshlrev_b32 v84, 16, v66
    v_and_b32 v85, 0xffff0000, v66
    v_lshlrev_b32 v86, 16, v67
    v_and_b32 v87, 0xffff0000, v67
    v_lshlrev_b32 v88, 16, v68
    v_and_b32 v89, 0xffff0000, v68
    v_lshlrev_b32 v90, 16, v69
    v_and_b32 v91, 0xffff0000, v69
    v_lshlrev_b32 v92, 16, v70
    v_and_b32 v93, 0xffff0000, v70
    v_lshlrev_b32 v94, 16, v71
    v_and_b32 v95, 0xffff0000, v71
    v_add_f32 v96, v80, v81
    v_add_f32 v97, v82, v83
    v_add_f32 v98, v84, v85
    v_add_f32 v99, v86, v87
    v_add_f32 v100, v88, v89
    v_add_f32 v101, v90, v91
    v_add_f32 v102, v92, v93
    buffer_load_dwordx4 a[4:7], v2, s[44:47], s26 offen offset:128 nt
    v_add_f32 v103, v94, v95
    v_add_f32 v96, v96, v100
    v_add_f32 v97, v97, v101
    v_add_f32 v98, v98, v102
    v_add_f32 v99, v99, v103
    v_add_f32 v96, v96, v98
    v_add_f32 v97, v97, v99
    v_add_f32 v113, v96, v97
    s_nop 1
    v_add_f32_dpp v113, v113, v113 row_ror:8 row_mask:0xf bank_mask:0xf
    s_nop 1
    v_add_f32_dpp v113, v113, v113 row_ror:4 row_mask:0xf bank_mask:0xf
    s_nop 1
    v_add_f32_dpp v113, v113, v113 row_ror:2 row_mask:0xf bank_mask:0xf
    s_nop 1
    v_add_f32_dpp v113, v113, v113 row_ror:1 row_mask:0xf bank_mask:0xf
    v_mov_b32 v115, v113
    s_nop 1
    v_permlane16_swap_b32 v113, v115
    v_add_f32 v113, v113, v115
    v_mov_b32 v115, v113
    s_nop 1
    v_permlane32_swap_b32 v113, v115
    v_add_f32 v113, v113, v115
    v_mul_f32 v113, 0x3a800000, v113
    v_sub_f32 v96, v80, v113
    v_sub_f32 v97, v81, v113
    v_sub_f32 v98, v82, v113
    buffer_load_dwordx4 a[8:11], v2, s[44:47], s26 offen offset:2048 nt
    v_sub_f32 v99, v83, v113
    v_sub_f32 v100, v84, v113
    v_sub_f32 v101, v85, v113
    v_sub_f32 v102, v86, v113
    v_sub_f32 v103, v87, v113
    v_sub_f32 v104, v88, v113
    v_sub_f32 v105, v89, v113
    v_sub_f32 v106, v90, v113
    v_sub_f32 v107, v91, v113
    v_sub_f32 v108, v92, v113
    v_sub_f32 v109, v93, v113
    v_sub_f32 v110, v94, v113
    v_sub_f32 v111, v95, v113
    v_mul_f32 v112, v96, v96
    v_mul_f32 v114, v97, v97
    v_fmac_f32 v112, v98, v98
    v_fmac_f32 v114, v99, v99
    v_fmac_f32 v112, v100, v100
    v_fmac_f32 v114, v101, v101
    v_fmac_f32 v112, v102, v102
    v_fmac_f32 v114, v103, v103
    v_fmac_f32 v112, v104, v104
    buffer_load_dwordx4 a[12:15], v2, s[44:47], s26 offen offset:2176 nt
    v_fmac_f32 v114, v105, v105
    v_fmac_f32 v112, v106, v106
    v_fmac_f32 v114, v107, v107
    v_fmac_f32 v112, v108, v108
    v_fmac_f32 v114, v109, v109
    v_fmac_f32 v112, v110, v110
    v_fmac_f32 v114, v111, v111
    v_add_f32 v112, v112, v114
    s_nop 1
    v_add_f32_dpp v112, v112, v112 row_ror:8 row_mask:0xf bank_mask:0xf
    s_nop 1
    v_add_f32_dpp v112, v112, v112 row_ror:4 row_mask:0xf bank_mask:0xf
    s_nop 1
    v_add_f32_dpp v112, v112, v112 row_ror:2 row_mask:0xf bank_mask:0xf
    s_nop 1
    v_add_f32_dpp v112, v112, v112 row_ror:1 row_mask:0xf bank_mask:0xf
    v_mov_b32 v115, v112
    s_nop 1
    v_permlane16_swap_b32 v112, v115
    v_add_f32 v112, v112, v115
    v_mov_b32 v115, v112
    s_nop 1
    v_permlane32_swap_b32 v112, v115
    v_add_f32 v112, v112, v115
    v_mul_f32 v112, 0x3a800000, v112
    v_cvt_pk_bf16_f32 v113, v113, v113
    v_lshlrev_b32 v113, 16, v113
    v_cvt_pk_bf16_f32 v112, v112, v112
    s_add_u32 s26, s38, 1
    s_and_b32 s26, s26, 15
    s_lshl_b32 s26, s26, 18
    buffer_load_dwordx4 a[16:19], v2, s[44:47], s26 offen offset:0 nt
    v_lshlrev_b32 v112, 16, v112
    v_add_f32 v112, 0x3727c5ac, v112
    v_cvt_pk_bf16_f32 v112, v112, v112
    v_lshlrev_b32 v112, 16, v112
    v_sqrt_f32 v112, v112
    s_nop 0
    v_cvt_pk_bf16_f32 v112, v112, v112
    v_lshlrev_b32 v112, 16, v112
    v_rcp_f32 v114, v112
    v_sub_f32 v96, v80, v113
    v_sub_f32 v97, v81, v113
    v_sub_f32 v98, v82, v113
    v_sub_f32 v99, v83, v113
    v_sub_f32 v100, v84, v113
    v_sub_f32 v101, v85, v113
    v_sub_f32 v102, v86, v113
    v_sub_f32 v103, v87, v113
    v_sub_f32 v104, v88, v113
    v_sub_f32 v105, v89, v113
    v_sub_f32 v106, v90, v113
    v_sub_f32 v107, v91, v113
    v_sub_f32 v108, v92, v113
    v_sub_f32 v109, v93, v113
    buffer_load_dwordx4 a[20:23], v2, s[44:47], s26 offen offset:128 nt
    v_sub_f32 v110, v94, v113
    v_sub_f32 v111, v95, v113
    s_waitcnt lgkmcnt(0)
    v_cvt_pk_bf16_f32 v64, v96, v97
    v_cvt_pk_bf16_f32 v65, v98, v99
    v_cvt_pk_bf16_f32 v66, v100, v101
    v_cvt_pk_bf16_f32 v67, v102, v103
    v_cvt_pk_bf16_f32 v68, v104, v105
    v_cvt_pk_bf16_f32 v69, v106, v107
    v_cvt_pk_bf16_f32 v70, v108, v109
    v_cvt_pk_bf16_f32 v71, v110, v111
    v_lshlrev_b32 v96, 16, v64
    v_and_b32 v97, 0xffff0000, v64
    v_lshlrev_b32 v98, 16, v65
    v_and_b32 v99, 0xffff0000, v65
    v_lshlrev_b32 v100, 16, v66
    v_and_b32 v101, 0xffff0000, v66
    v_lshlrev_b32 v102, 16, v67
    v_and_b32 v103, 0xffff0000, v67
    v_lshlrev_b32 v104, 16, v68
    v_and_b32 v105, 0xffff0000, v68
    v_lshlrev_b32 v106, 16, v69
    s_add_u32 m0, s89, 32768
    s_add_u32 s27, s1, 0
    buffer_load_dwordx4 v57, s[56:59], s27 offen nt lds
    v_and_b32 v107, 0xffff0000, v69
    v_lshlrev_b32 v108, 16, v70
    v_and_b32 v109, 0xffff0000, v70
    v_lshlrev_b32 v110, 16, v71
    v_and_b32 v111, 0xffff0000, v71
    v_mul_f32 v80, v96, v114
    v_mul_f32 v81, v97, v114
    v_mul_f32 v82, v98, v114
    v_mul_f32 v83, v99, v114
    v_mul_f32 v84, v100, v114
    v_mul_f32 v85, v101, v114
    v_mul_f32 v86, v102, v114
    v_mul_f32 v87, v103, v114
    v_mul_f32 v88, v104, v114
    v_mul_f32 v89, v105, v114
    v_mul_f32 v90, v106, v114
    v_mul_f32 v91, v107, v114
    v_mul_f32 v92, v108, v114
    v_mul_f32 v93, v109, v114
    v_mul_f32 v94, v110, v114
    v_mul_f32 v95, v111, v114
    v_fma_f32 v96, -v80, v112, v96
    buffer_load_dwordx4 a[24:27], v2, s[44:47], s26 offen offset:2048 nt
    v_fma_f32 v97, -v81, v112, v97
    v_fma_f32 v98, -v82, v112, v98
    v_fma_f32 v99, -v83, v112, v99
    v_fma_f32 v100, -v84, v112, v100
    v_fma_f32 v101, -v85, v112, v101
    v_fma_f32 v102, -v86, v112, v102
    v_fma_f32 v103, -v87, v112, v103
    v_fma_f32 v104, -v88, v112, v104
    v_fma_f32 v105, -v89, v112, v105
    v_fma_f32 v106, -v90, v112, v106
    v_fma_f32 v107, -v91, v112, v107
    v_fma_f32 v108, -v92, v112, v108
    v_fma_f32 v109, -v93, v112, v109
    v_fma_f32 v110, -v94, v112, v110
    v_fma_f32 v111, -v95, v112, v111
    v_fma_f32 v80, v96, v114, v80
    v_fma_f32 v81, v97, v114, v81
    v_fma_f32 v82, v98, v114, v82
    v_fma_f32 v83, v99, v114, v83
    v_fma_f32 v84, v100, v114, v84
    v_fma_f32 v85, v101, v114, v85
    v_fma_f32 v86, v102, v114, v86
    buffer_load_dwordx4 a[28:31], v2, s[44:47], s26 offen offset:2176 nt
    v_fma_f32 v87, v103, v114, v87
    v_fma_f32 v88, v104, v114, v88
    v_fma_f32 v89, v105, v114, v89
    v_fma_f32 v90, v106, v114, v90
    v_fma_f32 v91, v107, v114, v91
    v_fma_f32 v92, v108, v114, v92
    v_fma_f32 v93, v109, v114, v93
    v_fma_f32 v94, v110, v114, v94
    v_fma_f32 v95, v111, v114, v95
    v_cvt_pk_bf16_f32 v64, v80, v81
    v_cvt_pk_bf16_f32 v65, v82, v83
    v_cvt_pk_bf16_f32 v66, v84, v85
    v_cvt_pk_bf16_f32 v67, v86, v87
    v_cvt_pk_bf16_f32 v68, v88, v89
    v_cvt_pk_bf16_f32 v69, v90, v91
    v_cvt_pk_bf16_f32 v70, v92, v93
    v_cvt_pk_bf16_f32 v71, v94, v95
    v_add_u32 v115, 131072, v3
    ds_write_b128 v115, v[64:67]
    ds_write_b128 v115, v[68:71] offset:1024
    v_lshlrev_b32 v80, 16, v64
    s_add_u32 s26, s38, 2
    s_and_b32 s26, s26, 15
    s_lshl_b32 s26, s26, 18
    buffer_load_dwordx4 a[32:35], v2, s[44:47], s26 offen offset:0 nt
    v_and_b32 v81, 0xffff0000, v64
    v_lshlrev_b32 v82, 16, v65
    v_and_b32 v83, 0xffff0000, v65
    v_lshlrev_b32 v84, 16, v66
    v_and_b32 v85, 0xffff0000, v66
    v_lshlrev_b32 v86, 16, v67
    v_and_b32 v87, 0xffff0000, v67
    v_lshlrev_b32 v88, 16, v68
    v_and_b32 v89, 0xffff0000, v68
    v_lshlrev_b32 v90, 16, v69
    v_and_b32 v91, 0xffff0000, v69
    v_lshlrev_b32 v92, 16, v70
    v_and_b32 v93, 0xffff0000, v70
    v_lshlrev_b32 v94, 16, v71
    v_and_b32 v95, 0xffff0000, v71
    v_add_f32 v96, v80, v81
    v_add_f32 v97, v82, v83
    v_add_f32 v98, v84, v85
    v_add_f32 v99, v86, v87
    v_add_f32 v100, v88, v89
    v_add_f32 v101, v90, v91
    v_add_f32 v102, v92, v93
    buffer_load_dwordx4 a[36:39], v2, s[44:47], s26 offen offset:128 nt
    v_add_f32 v103, v94, v95
    v_add_f32 v96, v96, v100
    v_add_f32 v97, v97, v101
    v_add_f32 v98, v98, v102
    v_add_f32 v99, v99, v103
    v_add_f32 v96, v96, v98
    v_add_f32 v97, v97, v99
    v_add_f32 v113, v96, v97
    s_nop 1
    v_add_f32_dpp v113, v113, v113 row_ror:8 row_mask:0xf bank_mask:0xf
    s_nop 1
    v_add_f32_dpp v113, v113, v113 row_ror:4 row_mask:0xf bank_mask:0xf
    s_nop 1
    v_add_f32_dpp v113, v113, v113 row_ror:2 row_mask:0xf bank_mask:0xf
    s_nop 1
    v_add_f32_dpp v113, v113, v113 row_ror:1 row_mask:0xf bank_mask:0xf
    v_mov_b32 v115, v113
    s_nop 1
    v_permlane16_swap_b32 v113, v115
    v_add_f32 v113, v113, v115
    v_mov_b32 v115, v113
    s_nop 1
    v_permlane32_swap_b32 v113, v115
    v_add_f32 v113, v113, v115
    v_mul_f32 v113, 0x3a800000, v113
    v_sub_f32 v96, v80, v113
    v_sub_f32 v97, v81, v113
    v_sub_f32 v98, v82, v113
    buffer_load_dwordx4 a[40:43], v2, s[44:47], s26 offen offset:2048 nt
    v_sub_f32 v99, v83, v113
    v_sub_f32 v100, v84, v113
    v_sub_f32 v101, v85, v113
    v_sub_f32 v102, v86, v113
    v_sub_f32 v103, v87, v113
    v_sub_f32 v104, v88, v113
    v_sub_f32 v105, v89, v113
    v_sub_f32 v106, v90, v113
    v_sub_f32 v107, v91, v113
    v_sub_f32 v108, v92, v113
    v_sub_f32 v109, v93, v113
    v_sub_f32 v110, v94, v113
    v_sub_f32 v111, v95, v113
    v_mul_f32 v112, v96, v96
    v_mul_f32 v114, v97, v97
    v_fmac_f32 v112, v98, v98
    v_fmac_f32 v114, v99, v99
    v_fmac_f32 v112, v100, v100
    v_fmac_f32 v114, v101, v101
    v_fmac_f32 v112, v102, v102
    v_fmac_f32 v114, v103, v103
    v_fmac_f32 v112, v104, v104
    buffer_load_dwordx4 a[44:47], v2, s[44:47], s26 offen offset:2176 nt
    v_fmac_f32 v114, v105, v105
    v_fmac_f32 v112, v106, v106
    v_fmac_f32 v114, v107, v107
    v_fmac_f32 v112, v108, v108
    v_fmac_f32 v114, v109, v109
    v_fmac_f32 v112, v110, v110
    v_fmac_f32 v114, v111, v111
    v_add_f32 v112, v112, v114
    s_nop 1
    v_add_f32_dpp v112, v112, v112 row_ror:8 row_mask:0xf bank_mask:0xf
    s_nop 1
    v_add_f32_dpp v112, v112, v112 row_ror:4 row_mask:0xf bank_mask:0xf
    s_nop 1
    v_add_f32_dpp v112, v112, v112 row_ror:2 row_mask:0xf bank_mask:0xf
    s_nop 1
    v_add_f32_dpp v112, v112, v112 row_ror:1 row_mask:0xf bank_mask:0xf
    v_mov_b32 v115, v112
    s_nop 1
    v_permlane16_swap_b32 v112, v115
    v_add_f32 v112, v112, v115
    v_mov_b32 v115, v112
    s_nop 1
    v_permlane32_swap_b32 v112, v115
    v_add_f32 v112, v112, v115
    v_mul_f32 v112, 0x3a800000, v112
    v_cvt_pk_bf16_f32 v113, v113, v113
    v_lshlrev_b32 v113, 16, v113
    v_cvt_pk_bf16_f32 v112, v112, v112
    s_add_u32 m0, s89, 33792
    s_add_u32 s27, s1, 57344
    buffer_load_dwordx4 v57, s[56:59], s27 offen nt lds
    v_lshlrev_b32 v112, 16, v112
    v_add_f32 v112, 0x3727c5ac, v112
    v_cvt_pk_bf16_f32 v112, v112, v112
    v_lshlrev_b32 v112, 16, v112
    v_sqrt_f32 v112, v112
    s_nop 0
    v_cvt_pk_bf16_f32 v112, v112, v112
    v_lshlrev_b32 v112, 16, v112
    v_rcp_f32 v114, v112
    v_sub_f32 v96, v80, v113
    v_sub_f32 v97, v81, v113
    v_sub_f32 v98, v82, v113
    v_sub_f32 v99, v83, v113
    v_sub_f32 v100, v84, v113
    v_sub_f32 v101, v85, v113
    v_sub_f32 v102, v86, v113
    v_sub_f32 v103, v87, v113
    v_sub_f32 v104, v88, v113
    v_sub_f32 v105, v89, v113
    v_sub_f32 v106, v90, v113
    v_sub_f32 v107, v91, v113
    v_sub_f32 v108, v92, v113
    v_sub_f32 v109, v93, v113
    s_add_u32 s26, s38, 3
    s_and_b32 s26, s26, 15
    s_lshl_b32 s26, s26, 18
    buffer_load_dwordx4 a[48:51], v2, s[44:47], s26 offen offset:0 nt
    v_sub_f32 v110, v94, v113
    v_sub_f32 v111, v95, v113
    s_waitcnt lgkmcnt(0)
    v_cvt_pk_bf16_f32 v64, v96, v97
    v_cvt_pk_bf16_f32 v65, v98, v99
    v_cvt_pk_bf16_f32 v66, v100, v101
    v_cvt_pk_bf16_f32 v67, v102, v103
    v_cvt_pk_bf16_f32 v68, v104, v105
    v_cvt_pk_bf16_f32 v69, v106, v107
    v_cvt_pk_bf16_f32 v70, v108, v109
    v_cvt_pk_bf16_f32 v71, v110, v111
    v_lshlrev_b32 v96, 16, v64
    v_and_b32 v97, 0xffff0000, v64
    v_lshlrev_b32 v98, 16, v65
    v_and_b32 v99, 0xffff0000, v65
    v_lshlrev_b32 v100, 16, v66
    v_and_b32 v101, 0xffff0000, v66
    v_lshlrev_b32 v102, 16, v67
    v_and_b32 v103, 0xffff0000, v67
    v_lshlrev_b32 v104, 16, v68
    v_and_b32 v105, 0xffff0000, v68
    v_lshlrev_b32 v106, 16, v69
    buffer_load_dwordx4 a[52:55], v2, s[44:47], s26 offen offset:128 nt
    v_and_b32 v107, 0xffff0000, v69
    v_lshlrev_b32 v108, 16, v70
    v_and_b32 v109, 0xffff0000, v70
    v_lshlrev_b32 v110, 16, v71
    v_and_b32 v111, 0xffff0000, v71
    v_mul_f32 v80, v96, v114
    v_mul_f32 v81, v97, v114
    v_mul_f32 v82, v98, v114
    v_mul_f32 v83, v99, v114
    v_mul_f32 v84, v100, v114
    v_mul_f32 v85, v101, v114
    v_mul_f32 v86, v102, v114
    v_mul_f32 v87, v103, v114
    v_mul_f32 v88, v104, v114
    v_mul_f32 v89, v105, v114
    v_mul_f32 v90, v106, v114
    v_mul_f32 v91, v107, v114
    v_mul_f32 v92, v108, v114
    v_mul_f32 v93, v109, v114
    v_mul_f32 v94, v110, v114
    v_mul_f32 v95, v111, v114
    v_fma_f32 v96, -v80, v112, v96
    buffer_load_dwordx4 a[56:59], v2, s[44:47], s26 offen offset:2048 nt
    v_fma_f32 v97, -v81, v112, v97
    v_fma_f32 v98, -v82, v112, v98
    v_fma_f32 v99, -v83, v112, v99
    v_fma_f32 v100, -v84, v112, v100
    v_fma_f32 v101, -v85, v112, v101
    v_fma_f32 v102, -v86, v112, v102
    v_fma_f32 v103, -v87, v112, v103
    v_fma_f32 v104, -v88, v112, v104
    v_fma_f32 v105, -v89, v112, v105
    v_fma_f32 v106, -v90, v112, v106
    v_fma_f32 v107, -v91, v112, v107
    v_fma_f32 v108, -v92, v112, v108
    v_fma_f32 v109, -v93, v112, v109
    v_fma_f32 v110, -v94, v112, v110
    v_fma_f32 v111, -v95, v112, v111
    v_fma_f32 v80, v96, v114, v80
    v_fma_f32 v81, v97, v114, v81
    v_fma_f32 v82, v98, v114, v82
    v_fma_f32 v83, v99, v114, v83
    v_fma_f32 v84, v100, v114, v84
    v_fma_f32 v85, v101, v114, v85
    v_fma_f32 v86, v102, v114, v86
    buffer_load_dwordx4 a[60:63], v2, s[44:47], s26 offen offset:2176 nt
    v_fma_f32 v87, v103, v114, v87
    v_fma_f32 v88, v104, v114, v88
    v_fma_f32 v89, v105, v114, v89
    v_fma_f32 v90, v106, v114, v90
    v_fma_f32 v91, v107, v114, v91
    v_fma_f32 v92, v108, v114, v92
    v_fma_f32 v93, v109, v114, v93
    v_fma_f32 v94, v110, v114, v94
    v_fma_f32 v95, v111, v114, v95
    v_cvt_pk_bf16_f32 v64, v80, v81
    v_cvt_pk_bf16_f32 v65, v82, v83
    v_cvt_pk_bf16_f32 v66, v84, v85
    v_cvt_pk_bf16_f32 v67, v86, v87
    v_cvt_pk_bf16_f32 v68, v88, v89
    v_cvt_pk_bf16_f32 v69, v90, v91
    v_cvt_pk_bf16_f32 v70, v92, v93
    v_cvt_pk_bf16_f32 v71, v94, v95
    v_add_u32 v115, 139264, v3
    ds_write_b128 v115, v[64:67]
    ds_write_b128 v115, v[68:71] offset:1024
    s_lshl_b32 s72, s3, 12
    v_add_u32 v3, s72, v4
    s_waitcnt vmcnt(18)
    s_mov_b32 s72, 1664525
    v_mul_lo_u32 v13, v5, s72
    v_add_u32 v13, 1013904223, v13
    v_lshrrev_b32 v14, 13, v13
    v_xor_b32 v13, v13, v14
    v_and_b32 v13, 0x7e7e7e7e, v13
    v_or_b32 v13, 0x01010101, v13
    v_add_u32 v5, v5, v13
    s_cmp_lg_u32 s3, 0
    s_cbranch_scc1 L_w0_rg
    s_lshl_b32 s72, s87, 4
    s_lshl_b32 s73, s79, 7
    s_add_u32 s72, s72, s73
    s_add_u32 s72, s72, 3407872
    v_mov_b32 v30, s80
    v_mov_b32 v31, v5
    v_lshlrev_b32 v13, 3, v1
    s_mov_b64 exec, 0xffff
    buffer_store_dwordx2 v[30:31], v13, s[68:71], s72 offen
    s_mov_b64 exec, -1
L_w0_rg:
    s_lshl_b32 s72, s3, 5
    v_add_u32 v116, s72, v6
    v_and_b32 v13, 3, v1
    v_lshlrev_b32 v13, 11, v13
    v_add_u32 v13, v13, v10
    s_lshl_b32 s72, s77, 9
    s_add_u32 s72, s72, 131072
    v_add_u32 v117, s72, v13
    s_lshl_b32 s72, s43, 9
    s_add_u32 s72, s72, 131072
    v_add_u32 v125, s72, v13
    v_add_u32 v118, 32768, v116
    s_waitcnt lgkmcnt(0)
    s_barrier
    ds_read_b64_tr_b16 v[128:129], v116 offset:0
    s_add_u32 s26, s38, 4
    s_and_b32 s26, s26, 15
    s_lshl_b32 s26, s26, 18
    buffer_load_dwordx4 a[64:67], v2, s[44:47], s26 offen offset:0 nt
    ds_read_b64_tr_b16 v[130:131], v116 offset:512
    ds_read_b128 v[160:163], v117 offset:0
    ds_read_b64_tr_b16 v[132:133], v116 offset:4096
    ds_read_b64_tr_b16 v[134:135], v116 offset:4608
    ds_read_b128 v[164:167], v117 offset:64
    ds_read_b64_tr_b16 v[136:137], v116 offset:8192
    ds_read_b64_tr_b16 v[138:139], v116 offset:8704
    ds_read_b128 v[168:171], v117 offset:128
    ds_read_b64_tr_b16 v[140:141], v116 offset:12288
    ds_read_b64_tr_b16 v[142:143], v116 offset:12800
    buffer_load_dwordx4 a[68:71], v2, s[44:47], s26 offen offset:128 nt
    ds_read_b128 v[172:175], v117 offset:192
    s_waitcnt lgkmcnt(0)
    ds_read_b64_tr_b16 v[144:145], v116 offset:16384
    ds_read_b64_tr_b16 v[146:147], v116 offset:16896
    ds_read_b128 v[176:179], v117 offset:256
    ds_read_b64_tr_b16 v[148:149], v116 offset:20480
    ds_read_b64_tr_b16 v[150:151], v116 offset:20992
    ds_read_b128 v[180:183], v117 offset:320
    ds_read_b64_tr_b16 v[152:153], v116 offset:24576
    ds_read_b64_tr_b16 v[154:155], v116 offset:25088
    s_add_u32 m0, s89, 34816
    s_add_u32 s27, s1, 114688
    buffer_load_dwordx4 v57, s[56:59], s27 offen nt lds
    ds_read_b128 v[184:187], v117 offset:384
    ds_read_b64_tr_b16 v[156:157], v116 offset:28672
    ds_read_b64_tr_b16 v[158:159], v116 offset:29184
    ds_read_b128 v[188:191], v117 offset:448
    s_waitcnt lgkmcnt(0)
    v_mfma_f32_16x16x32_bf16 v[24:27], v[160:163], v[128:131], 0
    v_mfma_f32_16x16x32_bf16 v[24:27], v[164:167], v[132:135], v[24:27]
    v_mfma_f32_16x16x32_bf16 v[24:27], v[168:171], v[136:139], v[24:27]
    v_mfma_f32_16x16x32_bf16 v[24:27], v[172:175], v[140:143], v[24:27]
    v_mfma_f32_16x16x32_bf16 v[24:27], v[176:179], v[144:147], v[24:27]
    buffer_load_dwordx4 a[72:75], v2, s[44:47], s26 offen offset:2048 nt
    v_mfma_f32_16x16x32_bf16 v[24:27], v[180:183], v[148:151], v[24:27]
    v_mfma_f32_16x16x32_bf16 v[24:27], v[184:187], v[152:155], v[24:27]
    v_mfma_f32_16x16x32_bf16 v[24:27], v[188:191], v[156:159], v[24:27]
    v_bfe_u32 v120, v5, 0, 8
    v_bfe_u32 v121, v5, 8, 8
    v_bfe_u32 v122, v5, 16, 8
    v_bfe_u32 v124, v5, 24, 8
    s_lshl_b32 s72, s77, 14
    s_lshl_b32 s73, s78, 8
    s_add_u32 s72, s72, s73
    s_lshl_b32 s73, s3, 6
    v_and_b32 v13, 15, v1
    v_lshlrev_b32 v13, 1, v13
    v_lshrrev_b32 v37, v13, v5
    v_and_b32 v13, 3, v1
    v_lshlrev_b32 v13, 3, v13
    v_lshrrev_b32 v13, v13, v5
    v_bfe_u32 v112, v13, 0, 2
    v_bfe_u32 v113, v13, 2, 2
    v_bfe_u32 v114, v13, 4, 2
    v_bfe_u32 v115, v13, 6, 2
    s_add_u32 s72, s72, s73
    s_add_u32 s72, s72, 1048576
    v_mov_b32 v36, v24
    s_nop 1
    v_mov_b32_dpp v36, v25 quad_perm:[0,1,2,3] row_mask:0x2 bank_mask:0xf
    s_nop 1
    v_mov_b32_dpp v36, v26 quad_perm:[0,1,2,3] row_mask:0x4 bank_mask:0xf
    s_nop 1
    v_mov_b32_dpp v36, v27 quad_perm:[0,1,2,3] row_mask:0x8 bank_mask:0xf
    v_add_u32 v36, 2, v36
    v_bfi_b32 v36, 3, v37, v36
    buffer_store_dword v36, v7, s[68:71], s72 offen sc1
    v_lshlrev_b32 v119, 4, v0
    s_lshl_b32 s72, s87, 4
    s_add_u32 s72, s72, 3407872
    v_and_b32 v15, 31, v1
    v_lshlrev_b32 v15, 7, v15
    v_add_u32 v62, s72, v15
    s_lshl_b32 s72, s74, 16
    s_lshl_b32 s73, s75, 12
    s_add_u32 s72, s72, s73
    s_add_u32 s72, s72, 1048576
    buffer_load_dwordx4 a[76:79], v2, s[44:47], s26 offen offset:2176 nt
    s_add_u32 s26, s38, 5
    s_and_b32 s26, s26, 15
    s_lshl_b32 s26, s26, 18
    buffer_load_dwordx4 a[80:83], v2, s[44:47], s26 offen offset:0 nt
    buffer_load_dwordx4 a[84:87], v2, s[44:47], s26 offen offset:128 nt
    buffer_load_dwordx4 a[88:91], v2, s[44:47], s26 offen offset:2048 nt
    s_waitcnt vmcnt(6)
    buffer_load_dwordx4 a[92:95], v2, s[44:47], s26 offen offset:2176 nt
    s_waitcnt vmcnt(6)
    s_add_u32 m0, s89, 35840
    s_add_u32 s27, s1, 172032
    buffer_load_dwordx4 v57, s[56:59], s27 offen nt lds
    s_waitcnt vmcnt(6)
    s_add_u32 s26, s38, 6
    s_and_b32 s26, s26, 15
    s_lshl_b32 s26, s26, 18
    buffer_load_dwordx4 a[96:99], v2, s[44:47], s26 offen offset:0 nt
    s_waitcnt vmcnt(6)
    buffer_load_dwordx4 a[100:103], v2, s[44:47], s26 offen offset:128 nt
    s_waitcnt vmcnt(6)
    buffer_load_dwordx4 a[104:107], v2, s[44:47], s26 offen offset:2048 nt
    s_waitcnt vmcnt(6)
    buffer_load_dwordx4 a[108:111], v2, s[44:47], s26 offen offset:2176 nt
    s_waitcnt vmcnt(6)
    s_add_u32 s26, s38, 7
    s_and_b32 s26, s26, 15
    s_lshl_b32 s26, s26, 18
    buffer_load_dwordx4 a[112:115], v2, s[44:47], s26 offen offset:0 nt
    s_waitcnt vmcnt(6)
    buffer_load_dwordx4 a[116:119], v2, s[44:47], s26 offen offset:128 nt
    s_waitcnt vmcnt(6)
    s_add_u32 m0, s89, 36864
    s_add_u32 s27, s1, 229376
    buffer_load_dwordx4 v57, s[56:59], s27 offen nt lds
    s_waitcnt vmcnt(6)
    buffer_load_dwordx4 a[120:123], v2, s[44:47], s26 offen offset:2048 nt
    s_waitcnt vmcnt(6)
    buffer_load_dwordx4 a[124:127], v2, s[44:47], s26 offen offset:2176 nt
    s_waitcnt vmcnt(6)
    s_add_u32 s26, s38, 8
    s_and_b32 s26, s26, 15
    s_lshl_b32 s26, s26, 18
    buffer_load_dwordx4 a[128:131], v2, s[44:47], s26 offen offset:0 nt
    s_waitcnt vmcnt(6)
    buffer_load_dwordx4 a[132:135], v2, s[44:47], s26 offen offset:128 nt
    s_waitcnt vmcnt(6)
    buffer_load_dwordx4 a[136:139], v2, s[44:47], s26 offen offset:2048 nt
    s_waitcnt vmcnt(6)
    buffer_load_dwordx4 a[140:143], v2, s[44:47], s26 offen offset:2176 nt
    s_waitcnt vmcnt(6)
    s_add_u32 m0, s89, 37888
    s_add_u32 s27, s1, 286720
    buffer_load_dwordx4 v57, s[56:59], s27 offen nt lds
    s_waitcnt vmcnt(6)
    s_add_u32 s26, s38, 9
    s_and_b32 s26, s26, 15
    s_lshl_b32 s26, s26, 18
    buffer_load_dwordx4 a[144:147], v2, s[44:47], s26 offen offset:0 nt
    s_waitcnt vmcnt(6)
    buffer_load_dwordx4 a[148:151], v2, s[44:47], s26 offen offset:128 nt
    s_waitcnt vmcnt(6)
    buffer_load_dwordx4 a[152:155], v2, s[44:47], s26 offen offset:2048 nt
    s_waitcnt vmcnt(6)
    buffer_load_dwordx4 a[156:159], v2, s[44:47], s26 offen offset:2176 nt
    s_waitcnt vmcnt(6)
    s_add_u32 s26, s38, 10
    s_and_b32 s26, s26, 15
    s_lshl_b32 s26, s26, 18
    buffer_load_dwordx4 a[160:163], v2, s[44:47], s26 offen offset:0 nt
    s_waitcnt vmcnt(6)
    buffer_load_dwordx4 a[164:167], v2, s[44:47], s26 offen offset:128 nt
    s_waitcnt vmcnt(6)
    s_add_u32 m0, s89, 38912
    s_add_u32 s27, s1, 344064
    buffer_load_dwordx4 v57, s[56:59], s27 offen nt lds
    s_waitcnt vmcnt(6)
    buffer_load_dwordx4 a[168:171], v2, s[44:47], s26 offen offset:2048 nt
    s_waitcnt vmcnt(6)
    buffer_load_dwordx4 a[172:175], v2, s[44:47], s26 offen offset:2176 nt
    s_waitcnt vmcnt(6)
    s_add_u32 s26, s38, 11
    s_and_b32 s26, s26, 15
    s_lshl_b32 s26, s26, 18
    buffer_load_dwordx4 a[176:179], v2, s[44:47], s26 offen offset:0 nt
    s_waitcnt vmcnt(6)
    buffer_load_dwordx4 a[180:183], v2, s[44:47], s26 offen offset:128 nt
    s_waitcnt vmcnt(6)
    buffer_load_dwordx4 a[184:187], v2, s[44:47], s26 offen offset:2048 nt
    s_waitcnt vmcnt(6)
    buffer_load_dwordx4 a[188:191], v2, s[44:47], s26 offen offset:2176 nt
    buffer_load_dwordx2 v[60:61], v62, s[68:71], 0 offen sc1
    s_add_u32 s73, s72, 0
    buffer_load_dwordx4 v[64:67], v119, s[68:71], s73 offen
    s_add_u32 s73, s72, 16384
    buffer_load_dwordx4 v[68:71], v119, s[68:71], s73 offen
    s_add_u32 s73, s72, 32768
    buffer_load_dwordx4 v[72:75], v119, s[68:71], s73 offen
    s_add_u32 s73, s72, 49152
    buffer_load_dwordx4 v[76:79], v119, s[68:71], s73 offen
    s_waitcnt vmcnt(6)
    s_add_u32 m0, s89, 39936
    s_add_u32 s27, s1, 401408
    buffer_load_dwordx4 v57, s[56:59], s27 offen nt lds
    s_waitcnt vmcnt(6)
    s_add_u32 s26, s38, 12
    s_and_b32 s26, s26, 15
    s_lshl_b32 s26, s26, 18
    buffer_load_dwordx4 a[192:195], v2, s[44:47], s26 offen offset:0 nt
    s_waitcnt vmcnt(6)
    buffer_load_dwordx4 a[196:199], v2, s[44:47], s26 offen offset:128 nt
    s_waitcnt vmcnt(6)
    buffer_load_dwordx4 a[200:203], v2, s[44:47], s26 offen offset:2048 nt
    s_waitcnt vmcnt(6)
    buffer_load_dwordx4 a[204:207], v2, s[44:47], s26 offen offset:2176 nt
    s_waitcnt vmcnt(6)
    s_add_u32 s26, s38, 13
    s_and_b32 s26, s26, 15
    s_lshl_b32 s26, s26, 18
    buffer_load_dwordx4 a[208:211], v2, s[44:47], s26 offen offset:0 nt
    s_waitcnt vmcnt(6)
    buffer_load_dwordx4 a[212:215], v2, s[44:47], s26 offen offset:128 nt
    s_waitcnt vmcnt(6)
    buffer_load_dwordx4 a[216:219], v2, s[44:47], s26 offen offset:2048 nt
    s_waitcnt vmcnt(6)
    buffer_load_dwordx4 a[220:223], v2, s[44:47], s26 offen offset:2176 nt
    s_waitcnt vmcnt(6)
    s_add_u32 s26, s38, 14
    s_and_b32 s26, s26, 15
    s_lshl_b32 s26, s26, 18
    buffer_load_dwordx4 a[224:227], v2, s[44:47], s26 offen offset:0 nt
    s_waitcnt vmcnt(6)
    buffer_load_dwordx4 a[228:231], v2, s[44:47], s26 offen offset:128 nt
    s_waitcnt vmcnt(6)
    buffer_load_dwordx4 a[232:235], v2, s[44:47], s26 offen offset:2048 nt
    s_waitcnt vmcnt(6)
    buffer_load_dwordx4 a[236:239], v2, s[44:47], s26 offen offset:2176 nt
    s_waitcnt vmcnt(6)
    s_add_u32 s26, s38, 15
    s_and_b32 s26, s26, 15
    s_lshl_b32 s26, s26, 18
    buffer_load_dwordx4 a[240:243], v2, s[44:47], s26 offen offset:0 nt
    s_waitcnt vmcnt(6)
    buffer_load_dwordx4 a[244:247], v2, s[44:47], s26 offen offset:128 nt
    s_waitcnt vmcnt(6)
    buffer_load_dwordx4 a[248:251], v2, s[44:47], s26 offen offset:2048 nt
    s_waitcnt vmcnt(6)
    buffer_load_dwordx4 a[252:255], v2, s[44:47], s26 offen offset:2176 nt
    s_mov_b32 s88, 0
L_chk_qh:
    v_xor_b32 v84, v64, v112
    v_xor_b32 v85, v65, v113
    v_xor_b32 v86, v66, v114
    v_xor_b32 v87, v67, v115
    v_xor_b32 v88, v68, v112
    v_xor_b32 v89, v69, v113
    v_xor_b32 v90, v70, v114
    v_xor_b32 v91, v71, v115
    v_xor_b32 v92, v72, v112
    v_xor_b32 v93, v73, v113
    v_xor_b32 v94, v74, v114
    v_xor_b32 v95, v75, v115
    v_xor_b32 v96, v76, v112
    v_xor_b32 v97, v77, v113
    v_xor_b32 v98, v78, v114
    v_xor_b32 v99, v79, v115
    v_or_b32 v13, v84, v85
    v_or_b32 v14, v86, v87
    v_or3_b32 v13, v13, v88, v89
    v_or3_b32 v14, v14, v90, v91
    v_or3_b32 v13, v13, v92, v93
    v_or3_b32 v14, v14, v94, v95
    v_or3_b32 v13, v13, v96, v97
    v_or3_b32 v14, v14, v98, v99
    v_or_b32 v13, v13, v14
    v_and_b32 v13, 3, v13
    v_cmp_ne_u32 vcc, 0, v13
    s_cbranch_vccz L_ok_qh
    s_add_u32 s88, s88, 1
    s_cmp_gt_u32 s88, 262144
    s_cbranch_scc1 L_ok_qh
    v_or3_b32 v13, v84, v85, v86
    v_or_b32 v13, v13, v87
    s_nop 1
    v_or_b32_dpp v13, v13, v13 quad_perm:[1,0,3,2] row_mask:0xf bank_mask:0xf
    s_nop 1
    v_or_b32_dpp v13, v13, v13 quad_perm:[2,3,0,1] row_mask:0xf bank_mask:0xf
    v_and_b32 v13, 3, v13
    v_cmp_ne_u32 vcc, 0, v13
    s_cbranch_vccz L_skip_qh0
    s_mov_b64 exec, vcc
    s_add_u32 s73, s72, 0
    buffer_load_dwordx4 v[64:67], v119, s[68:71], s73 offen sc1
    s_mov_b64 exec, -1
L_skip_qh0:
    v_or3_b32 v13, v88, v89, v90
    v_or_b32 v13, v13, v91
    s_nop 1
    v_or_b32_dpp v13, v13, v13 quad_perm:[1,0,3,2] row_mask:0xf bank_mask:0xf
    s_nop 1
    v_or_b32_dpp v13, v13, v13 quad_perm:[2,3,0,1] row_mask:0xf bank_mask:0xf
    v_and_b32 v13, 3, v13
    v_cmp_ne_u32 vcc, 0, v13
    s_cbranch_vccz L_skip_qh1
    s_mov_b64 exec, vcc
    s_add_u32 s73, s72, 16384
    buffer_load_dwordx4 v[68:71], v119, s[68:71], s73 offen sc1
    s_mov_b64 exec, -1
L_skip_qh1:
    v_or3_b32 v13, v92, v93, v94
    v_or_b32 v13, v13, v95
    s_nop 1
    v_or_b32_dpp v13, v13, v13 quad_perm:[1,0,3,2] row_mask:0xf bank_mask:0xf
    s_nop 1
    v_or_b32_dpp v13, v13, v13 quad_perm:[2,3,0,1] row_mask:0xf bank_mask:0xf
    v_and_b32 v13, 3, v13
    v_cmp_ne_u32 vcc, 0, v13
    s_cbranch_vccz L_skip_qh2
    s_mov_b64 exec, vcc
    s_add_u32 s73, s72, 32768
    buffer_load_dwordx4 v[72:75], v119, s[68:71], s73 offen sc1
    s_mov_b64 exec, -1
L_skip_qh2:
    v_or3_b32 v13, v96, v97, v98
    v_or_b32 v13, v13, v99
    s_nop 1
    v_or_b32_dpp v13, v13, v13 quad_perm:[1,0,3,2] row_mask:0xf bank_mask:0xf
    s_nop 1
    v_or_b32_dpp v13, v13, v13 quad_perm:[2,3,0,1] row_mask:0xf bank_mask:0xf
    v_and_b32 v13, 3, v13
    v_cmp_ne_u32 vcc, 0, v13
    s_cbranch_vccz L_skip_qh3
    s_mov_b64 exec, vcc
    s_add_u32 s73, s72, 49152
    buffer_load_dwordx4 v[76:79], v119, s[68:71], s73 offen sc1
    s_mov_b64 exec, -1
L_skip_qh3:
    s_waitcnt vmcnt(0)
    s_branch L_chk_qh
L_ok_qh:
    v_xor_b32 v60, s80, v60
    v_xor_b32 v61, v5, v61
    v_or_b32 v60, v60, v61
    v_cmp_ne_u32 vcc, 0, v60
    s_nop 0
    s_or_b32 s80, vcc_lo, vcc_hi
    v_add_f32 v84, v84, v88
    s_add_u32 s26, s38, 0
    s_and_b32 s26, s26, 15
    s_lshl_b32 s26, s26, 18
    buffer_load_dwordx4 v[128:131], v3, s[48:51], s26 offen offset:0 nt
    v_add_f32 v92, v92, v96
    v_add_f32 v85, v85, v89
    v_add_f32 v93, v93, v97
    v_add_f32 v86, v86, v90
    v_add_f32 v94, v94, v98
    v_add_f32 v87, v87, v91
    v_add_f32 v95, v95, v99
    v_add_f32 v84, v84, v92
    v_add_f32 v85, v85, v93
    v_add_f32 v86, v86, v94
    buffer_load_dwordx4 v[132:135], v3, s[48:51], s26 offen offset:1024 nt
    v_add_f32 v87, v87, v95
    v_cvt_pk_bf16_f32 v84, v84, v85
    v_cvt_pk_bf16_f32 v85, v86, v87
    v_lshlrev_b32 v13, 3, v0
    v_add_u32 v13, 147456, v13
    ds_write_b64 v13, v[84:85]
    v_and_b32 v13, 7, v1
    v_lshlrev_b32 v13, 8, v13
    v_lshl_add_u32 v13, v10, 1, v13
    v_bfe_u32 v15, v1, 3, 1
    buffer_load_dwordx4 v[136:139], v3, s[48:51], s26 offen offset:2048 nt
    v_lshl_add_u32 v13, v15, 4, v13
    v_add_u32 v13, 147456, v13
    buffer_load_dwordx4 v[140:143], v3, s[48:51], s26 offen offset:3072 nt
    s_add_u32 s26, s38, 1
    s_and_b32 s26, s26, 15
    s_lshl_b32 s26, s26, 18
    buffer_load_dwordx4 v[144:147], v3, s[48:51], s26 offen offset:0 nt
    s_waitcnt vmcnt(11)
    buffer_load_dwordx4 v[148:151], v3, s[48:51], s26 offen offset:1024 nt
    s_waitcnt vmcnt(11)
    buffer_load_dwordx4 v[152:155], v3, s[48:51], s26 offen offset:2048 nt
    s_waitcnt vmcnt(11)
    buffer_load_dwordx4 v[156:159], v3, s[48:51], s26 offen offset:3072 nt
    s_waitcnt lgkmcnt(0)
    s_barrier
    ds_read_b128 v[16:19], v13
    ds_read_b128 v[20:23], v13 offset:128
    v_mov_b32 v11, 0xff800000
    v_xor_b32 v8, 0x80, v9
    ds_read_b64_tr_b16 v[192:193], v116 offset:32768
    s_waitcnt vmcnt(11)
    s_add_u32 s26, s38, 2
    s_and_b32 s26, s26, 15
    s_lshl_b32 s26, s26, 18
    buffer_load_dwordx4 v[160:163], v3, s[48:51], s26 offen offset:0 nt
    ds_read_b64_tr_b16 v[194:195], v116 offset:33280
    ds_read_b128 v[224:227], v125 offset:8192
    ds_read_b64_tr_b16 v[196:197], v116 offset:36864
    ds_read_b64_tr_b16 v[198:199], v116 offset:37376
    ds_read_b128 v[228:231], v125 offset:8256
    ds_read_b64_tr_b16 v[200:201], v116 offset:40960
    ds_read_b64_tr_b16 v[202:203], v116 offset:41472
    ds_read_b128 v[232:235], v125 offset:8320
    ds_read_b64_tr_b16 v[204:205], v116 offset:45056
    ds_read_b64_tr_b16 v[206:207], v116 offset:45568
    ds_read_b128 v[236:239], v125 offset:8384
    s_waitcnt lgkmcnt(0)
    ds_read_b64_tr_b16 v[208:209], v116 offset:49152
    ds_read_b64_tr_b16 v[210:211], v116 offset:49664
    ds_read_b128 v[240:243], v125 offset:8448
    ds_read_b64_tr_b16 v[212:213], v116 offset:53248
    ds_read_b64_tr_b16 v[214:215], v116 offset:53760
    ds_read_b128 v[244:247], v125 offset:8512
    ds_read_b64_tr_b16 v[216:217], v116 offset:57344
    ds_read_b64_tr_b16 v[218:219], v116 offset:57856
    ds_read_b128 v[248:251], v125 offset:8576
    ds_read_b64_tr_b16 v[220:221], v116 offset:61440
    ds_read_b64_tr_b16 v[222:223], v116 offset:61952
    ds_read_b128 v[252:255], v125 offset:8640
    s_waitcnt lgkmcnt(0)
    v_mfma_f32_16x16x32_bf16 v[28:31], v[224:227], v[192:195], 0
    v_mfma_f32_16x16x32_bf16 v[28:31], v[228:231], v[196:199], v[28:31]
    v_mfma_f32_16x16x32_bf16 v[28:31], v[232:235], v[200:203], v[28:31]
    v_mfma_f32_16x16x32_bf16 v[28:31], v[236:239], v[204:207], v[28:31]
    v_mfma_f32_16x16x32_bf16 v[28:31], v[240:243], v[208:211], v[28:31]
    v_mfma_f32_16x16x32_bf16 v[28:31], v[244:247], v[212:215], v[28:31]
    v_mfma_f32_16x16x32_bf16 v[28:31], v[248:251], v[216:219], v[28:31]
    v_mfma_f32_16x16x32_bf16 v[28:31], v[252:255], v[220:223], v[28:31]
    s_lshl_b32 s73, s43, 16
    s_lshl_b32 s85, s0, 10
    s_add_u32 s73, s73, s85
    s_lshl_b32 s85, s3, 8
    s_add_u32 s73, s73, s85
    s_add_u32 s73, s73, 1572864
    s_movk_i32 s85, 0xff
    s_waitcnt vmcnt(11)
    buffer_load_dwordx4 v[164:167], v3, s[48:51], s26 offen offset:1024 nt
    v_add_u32 v28, 0x80, v28
    v_add_u32 v29, 0x80, v29
    v_add_u32 v30, 0x80, v30
    v_add_u32 v31, 0x80, v31
    v_bfi_b32 v28, s85, v120, v28
    v_bfi_b32 v29, s85, v121, v29
    v_bfi_b32 v30, s85, v122, v30
    v_bfi_b32 v31, s85, v124, v31
    s_mov_b64 exec, 0xffff
    s_cmp_eq_u32 s80, 0
    s_cbranch_scc1 L_pl_h
    buffer_store_dwordx4 v[28:31], v4, s[68:71], s73 offen sc1
    s_branch L_pd_h
L_pl_h:
    buffer_store_dwordx4 v[28:31], v4, s[68:71], s73 offen
L_pd_h:
    s_mov_b64 exec, -1
    s_waitcnt lgkmcnt(0)
    v_mfma_f32_16x16x32_bf16 v[24:27], a[0:3], v[16:19], 0
    buffer_load_dwordx4 v[168:171], v3, s[48:51], s26 offen offset:2048 nt
    v_mfma_f32_16x16x32_bf16 v[28:31], a[8:11], v[16:19], 0
    v_mfma_f32_16x16x32_bf16 v[32:35], a[16:19], v[16:19], 0
    v_mfma_f32_16x16x32_bf16 v[36:39], a[24:27], v[16:19], 0
    v_mfma_f32_16x16x32_bf16 v[24:27], a[4:7], v[20:23], v[24:27]
    v_mfma_f32_16x16x32_bf16 v[28:31], a[12:15], v[20:23], v[28:31]
    v_mfma_f32_16x16x32_bf16 v[32:35], a[20:23], v[20:23], v[32:35]
    v_mfma_f32_16x16x32_bf16 v[36:39], a[28:31], v[20:23], v[36:39]
    v_mfma_f32_16x16x32_bf16 v[40:43], a[32:35], v[16:19], 0
    v_mfma_f32_16x16x32_bf16 v[44:47], a[40:43], v[16:19], 0
    v_mfma_f32_16x16x32_bf16 v[48:51], a[48:51], v[16:19], 0
    v_mfma_f32_16x16x32_bf16 v[52:55], a[56:59], v[16:19], 0
    v_mfma_f32_16x16x32_bf16 v[40:43], a[36:39], v[20:23], v[40:43]
    v_mfma_f32_16x16x32_bf16 v[44:47], a[44:47], v[20:23], v[44:47]
    v_mfma_f32_16x16x32_bf16 v[48:51], a[52:55], v[20:23], v[48:51]
    v_mfma_f32_16x16x32_bf16 v[52:55], a[60:63], v[20:23], v[52:55]
    v_add_f32_dpp v64, v25, v24 row_ror:8 row_mask:0xf bank_mask:0xf
    v_add_f32_dpp v65, v27, v26 row_ror:8 row_mask:0xf bank_mask:0xf
    v_add_f32_dpp v66, v29, v28 row_ror:8 row_mask:0xf bank_mask:0xf
    v_add_f32_dpp v67, v31, v30 row_ror:8 row_mask:0xf bank_mask:0xf
    v_add_f32_dpp v68, v33, v32 row_ror:8 row_mask:0xf bank_mask:0xf
    v_add_f32_dpp v69, v35, v34 row_ror:8 row_mask:0xf bank_mask:0xf
    v_add_f32_dpp v70, v37, v36 row_ror:8 row_mask:0xf bank_mask:0xf
    v_add_f32_dpp v71, v39, v38 row_ror:8 row_mask:0xf bank_mask:0xf
    v_cvt_pk_bf16_f32 v56, v64, v65
    v_cvt_pk_bf16_f32 v57, v66, v67
    v_cvt_pk_bf16_f32 v58, v68, v69
    v_cvt_pk_bf16_f32 v59, v70, v71
    v_lshlrev_b32 v64, 16, v56
    v_and_b32 v65, 0xffff0000, v56
    v_lshlrev_b32 v66, 16, v57
    v_and_b32 v67, 0xffff0000, v57
    v_lshlrev_b32 v68, 16, v58
    v_and_b32 v69, 0xffff0000, v58
    v_lshlrev_b32 v70, 16, v59
    v_and_b32 v71, 0xffff0000, v59
    v_mul_f32 v64, s83, v64
    v_mul_f32 v65, s83, v65
    v_mul_f32 v66, s83, v66
    v_mul_f32 v67, s83, v67
    v_mul_f32 v68, s83, v68
    buffer_load_dwordx4 v[172:175], v3, s[48:51], s26 offen offset:3072 nt
    v_mul_f32 v69, s83, v69
    v_mul_f32 v70, s83, v70
    v_mul_f32 v71, s83, v71
    v_cvt_pk_bf16_f32 v56, v64, v65
    v_cvt_pk_bf16_f32 v57, v66, v67
    v_cvt_pk_bf16_f32 v58, v68, v69
    v_cvt_pk_bf16_f32 v59, v70, v71
    v_lshlrev_b32 v64, 16, v56
    v_and_b32 v65, 0xffff0000, v56
    v_lshlrev_b32 v66, 16, v57
    v_and_b32 v67, 0xffff0000, v57
    v_lshlrev_b32 v68, 16, v58
    v_and_b32 v69, 0xffff0000, v58
    v_lshlrev_b32 v70, 16, v59
    v_and_b32 v71, 0xffff0000, v59
    v_max3_f32 v11, v11, v64, v65
    v_max3_f32 v11, v11, v66, v67
    v_max3_f32 v11, v11, v68, v69
    v_max3_f32 v11, v11, v70, v71
    v_mfma_f32_16x16x32_bf16 v[24:27], a[64:67], v[16:19], 0
    v_mfma_f32_16x16x32_bf16 v[28:31], a[72:75], v[16:19], 0
    v_mfma_f32_16x16x32_bf16 v[32:35], a[80:83], v[16:19], 0
    v_mfma_f32_16x16x32_bf16 v[36:39], a[88:91], v[16:19], 0
    v_mfma_f32_16x16x32_bf16 v[24:27], a[68:71], v[20:23], v[24:27]
    v_mfma_f32_16x16x32_bf16 v[28:31], a[76:79], v[20:23], v[28:31]
    v_mfma_f32_16x16x32_bf16 v[32:35], a[84:87], v[20:23], v[32:35]
    v_mfma_f32_16x16x32_bf16 v[36:39], a[92:95], v[20:23], v[36:39]
    v_add_f32_dpp v72, v41, v40 row_ror:8 row_mask:0xf bank_mask:0xf
    v_add_f32_dpp v73, v43, v42 row_ror:8 row_mask:0xf bank_mask:0xf
    v_add_f32_dpp v74, v45, v44 row_ror:8 row_mask:0xf bank_mask:0xf
    v_add_f32_dpp v75, v47, v46 row_ror:8 row_mask:0xf bank_mask:0xf
    v_add_f32_dpp v76, v49, v48 row_ror:8 row_mask:0xf bank_mask:0xf
    v_add_f32_dpp v77, v51, v50 row_ror:8 row_mask:0xf bank_mask:0xf
    v_add_f32_dpp v78, v53, v52 row_ror:8 row_mask:0xf bank_mask:0xf
    v_add_f32_dpp v79, v55, v54 row_ror:8 row_mask:0xf bank_mask:0xf
    v_cvt_pk_bf16_f32 v56, v72, v73
    v_cvt_pk_bf16_f32 v57, v74, v75
    v_cvt_pk_bf16_f32 v58, v76, v77
    v_cvt_pk_bf16_f32 v59, v78, v79
    v_lshlrev_b32 v72, 16, v56
    s_add_u32 s26, s38, 3
    s_and_b32 s26, s26, 15
    s_lshl_b32 s26, s26, 18
    buffer_load_dwordx4 v[176:179], v3, s[48:51], s26 offen offset:0 nt
    v_and_b32 v73, 0xffff0000, v56
    v_lshlrev_b32 v74, 16, v57
    v_and_b32 v75, 0xffff0000, v57
    v_lshlrev_b32 v76, 16, v58
    v_and_b32 v77, 0xffff0000, v58
    v_lshlrev_b32 v78, 16, v59
    v_and_b32 v79, 0xffff0000, v59
    v_mul_f32 v72, s83, v72
    v_mul_f32 v73, s83, v73
    v_mul_f32 v74, s83, v74
    v_mul_f32 v75, s83, v75
    v_mul_f32 v76, s83, v76
    v_mul_f32 v77, s83, v77
    v_mul_f32 v78, s83, v78
    v_mul_f32 v79, s83, v79
    v_cvt_pk_bf16_f32 v56, v72, v73
    v_cvt_pk_bf16_f32 v57, v74, v75
    v_cvt_pk_bf16_f32 v58, v76, v77
    v_cvt_pk_bf16_f32 v59, v78, v79
    v_lshlrev_b32 v72, 16, v56
    v_and_b32 v73, 0xffff0000, v56
    v_lshlrev_b32 v74, 16, v57
    v_and_b32 v75, 0xffff0000, v57
    v_lshlrev_b32 v76, 16, v58
    v_and_b32 v77, 0xffff0000, v58
    v_lshlrev_b32 v78, 16, v59
    v_and_b32 v79, 0xffff0000, v59
    v_max3_f32 v11, v11, v72, v73
    v_max3_f32 v11, v11, v74, v75
    v_max3_f32 v11, v11, v76, v77
    v_max3_f32 v11, v11, v78, v79
    v_mfma_f32_16x16x32_bf16 v[40:43], a[96:99], v[16:19], 0
    v_mfma_f32_16x16x32_bf16 v[44:47], a[104:107], v[16:19], 0
    v_mfma_f32_16x16x32_bf16 v[48:51], a[112:115], v[16:19], 0
    v_mfma_f32_16x16x32_bf16 v[52:55], a[120:123], v[16:19], 0
    v_mfma_f32_16x16x32_bf16 v[40:43], a[100:103], v[20:23], v[40:43]
    v_mfma_f32_16x16x32_bf16 v[44:47], a[108:111], v[20:23], v[44:47]
    v_mfma_f32_16x16x32_bf16 v[48:51], a[116:119], v[20:23], v[48:51]
    v_mfma_f32_16x16x32_bf16 v[52:55], a[124:127], v[20:23], v[52:55]
    v_add_f32_dpp v80, v25, v24 row_ror:8 row_mask:0xf bank_mask:0xf
    buffer_load_dwordx4 v[180:183], v3, s[48:51], s26 offen offset:1024 nt
    v_add_f32_dpp v81, v27, v26 row_ror:8 row_mask:0xf bank_mask:0xf
    v_add_f32_dpp v82, v29, v28 row_ror:8 row_mask:0xf bank_mask:0xf
    v_add_f32_dpp v83, v31, v30 row_ror:8 row_mask:0xf bank_mask:0xf
    v_add_f32_dpp v84, v33, v32 row_ror:8 row_mask:0xf bank_mask:0xf
    v_add_f32_dpp v85, v35, v34 row_ror:8 row_mask:0xf bank_mask:0xf
    v_add_f32_dpp v86, v37, v36 row_ror:8 row_mask:0xf bank_mask:0xf
    v_add_f32_dpp v87, v39, v38 row_ror:8 row_mask:0xf bank_mask:0xf
    v_cvt_pk_bf16_f32 v56, v80, v81
    v_cvt_pk_bf16_f32 v57, v82, v83
    v_cvt_pk_bf16_f32 v58, v84, v85
    v_cvt_pk_bf16_f32 v59, v86, v87
    v_lshlrev_b32 v80, 16, v56
    v_and_b32 v81, 0xffff0000, v56
    v_lshlrev_b32 v82, 16, v57
    v_and_b32 v83, 0xffff0000, v57
    v_lshlrev_b32 v84, 16, v58
    v_and_b32 v85, 0xffff0000, v58
    v_lshlrev_b32 v86, 16, v59
    v_and_b32 v87, 0xffff0000, v59
    v_mul_f32 v80, s83, v80
    v_mul_f32 v81, s83, v81
    v_mul_f32 v82, s83, v82
    v_mul_f32 v83, s83, v83
    v_mul_f32 v84, s83, v84
    v_mul_f32 v85, s83, v85
    v_mul_f32 v86, s83, v86
    v_mul_f32 v87, s83, v87
    v_cvt_pk_bf16_f32 v56, v80, v81
    v_cvt_pk_bf16_f32 v57, v82, v83
    v_cvt_pk_bf16_f32 v58, v84, v85
    v_cvt_pk_bf16_f32 v59, v86, v87
    v_lshlrev_b32 v80, 16, v56
    v_and_b32 v81, 0xffff0000, v56
    v_lshlrev_b32 v82, 16, v57
    v_and_b32 v83, 0xffff0000, v57
    v_lshlrev_b32 v84, 16, v58
    v_and_b32 v85, 0xffff0000, v58
    v_lshlrev_b32 v86, 16, v59
    v_and_b32 v87, 0xffff0000, v59
    v_max3_f32 v11, v11, v80, v81
    s_waitcnt vmcnt(11)
    buffer_load_dwordx4 v[184:187], v3, s[48:51], s26 offen offset:2048 nt
    v_max3_f32 v11, v11, v82, v83
    v_max3_f32 v11, v11, v84, v85
    v_max3_f32 v11, v11, v86, v87
    v_mfma_f32_16x16x32_bf16 v[24:27], a[128:131], v[16:19], 0
    v_mfma_f32_16x16x32_bf16 v[28:31], a[136:139], v[16:19], 0
    v_mfma_f32_16x16x32_bf16 v[32:35], a[144:147], v[16:19], 0
    v_mfma_f32_16x16x32_bf16 v[36:39], a[152:155], v[16:19], 0
    v_mfma_f32_16x16x32_bf16 v[24:27], a[132:135], v[20:23], v[24:27]
    v_mfma_f32_16x16x32_bf16 v[28:31], a[140:143], v[20:23], v[28:31]
    v_mfma_f32_16x16x32_bf16 v[32:35], a[148:151], v[20:23], v[32:35]
    v_mfma_f32_16x16x32_bf16 v[36:39], a[156:159], v[20:23], v[36:39]
    v_add_f32_dpp v88, v41, v40 row_ror:8 row_mask:0xf bank_mask:0xf
    v_add_f32_dpp v89, v43, v42 row_ror:8 row_mask:0xf bank_mask:0xf
    v_add_f32_dpp v90, v45, v44 row_ror:8 row_mask:0xf bank_mask:0xf
    v_add_f32_dpp v91, v47, v46 row_ror:8 row_mask:0xf bank_mask:0xf
    v_add_f32_dpp v92, v49, v48 row_ror:8 row_mask:0xf bank_mask:0xf
    v_add_f32_dpp v93, v51, v50 row_ror:8 row_mask:0xf bank_mask:0xf
    v_add_f32_dpp v94, v53, v52 row_ror:8 row_mask:0xf bank_mask:0xf
    v_add_f32_dpp v95, v55, v54 row_ror:8 row_mask:0xf bank_mask:0xf
    v_cvt_pk_bf16_f32 v56, v88, v89
    v_cvt_pk_bf16_f32 v57, v90, v91
    v_cvt_pk_bf16_f32 v58, v92, v93
    v_cvt_pk_bf16_f32 v59, v94, v95
    v_lshlrev_b32 v88, 16, v56
    v_and_b32 v89, 0xffff0000, v56
    v_lshlrev_b32 v90, 16, v57
    v_and_b32 v91, 0xffff0000, v57
    v_lshlrev_b32 v92, 16, v58
    v_and_b32 v93, 0xffff0000, v58
    v_lshlrev_b32 v94, 16, v59
    v_and_b32 v95, 0xffff0000, v59
    v_mul_f32 v88, s83, v88
    v_mul_f32 v89, s83, v89
    v_mul_f32 v90, s83, v90
    v_mul_f32 v91, s83, v91
    v_mul_f32 v92, s83, v92
    v_mul_f32 v93, s83, v93
    v_mul_f32 v94, s83, v94
    v_mul_f32 v95, s83, v95
    v_cvt_pk_bf16_f32 v56, v88, v89
    s_waitcnt vmcnt(11)
    buffer_load_dwordx4 v[188:191], v3, s[48:51], s26 offen offset:3072 nt
    v_cvt_pk_bf16_f32 v57, v90, v91
    v_cvt_pk_bf16_f32 v58, v92, v93
    v_cvt_pk_bf16_f32 v59, v94, v95
    v_lshlrev_b32 v88, 16, v56
    v_and_b32 v89, 0xffff0000, v56
    v_lshlrev_b32 v90, 16, v57
    v_and_b32 v91, 0xffff0000, v57
    v_lshlrev_b32 v92, 16, v58
    v_and_b32 v93, 0xffff0000, v58
    v_lshlrev_b32 v94, 16, v59
    v_and_b32 v95, 0xffff0000, v59
    v_max3_f32 v11, v11, v88, v89
    v_max3_f32 v11, v11, v90, v91
    v_max3_f32 v11, v11, v92, v93
    v_max3_f32 v11, v11, v94, v95
    v_mfma_f32_16x16x32_bf16 v[40:43], a[160:163], v[16:19], 0
    v_mfma_f32_16x16x32_bf16 v[44:47], a[168:171], v[16:19], 0
    v_mfma_f32_16x16x32_bf16 v[48:51], a[176:179], v[16:19], 0
    v_mfma_f32_16x16x32_bf16 v[52:55], a[184:187], v[16:19], 0
    v_mfma_f32_16x16x32_bf16 v[40:43], a[164:167], v[20:23], v[40:43]
    v_mfma_f32_16x16x32_bf16 v[44:47], a[172:175], v[20:23], v[44:47]
    v_mfma_f32_16x16x32_bf16 v[48:51], a[180:183], v[20:23], v[48:51]
    v_mfma_f32_16x16x32_bf16 v[52:55], a[188:191], v[20:23], v[52:55]
    v_add_f32_dpp v96, v25, v24 row_ror:8 row_mask:0xf bank_mask:0xf
    v_add_f32_dpp v97, v27, v26 row_ror:8 row_mask:0xf bank_mask:0xf
    v_add_f32_dpp v98, v29, v28 row_ror:8 row_mask:0xf bank_mask:0xf
    v_add_f32_dpp v99, v31, v30 row_ror:8 row_mask:0xf bank_mask:0xf
    v_add_f32_dpp v100, v33, v32 row_ror:8 row_mask:0xf bank_mask:0xf
    v_add_f32_dpp v101, v35, v34 row_ror:8 row_mask:0xf bank_mask:0xf
    v_add_f32_dpp v102, v37, v36 row_ror:8 row_mask:0xf bank_mask:0xf
    v_add_f32_dpp v103, v39, v38 row_ror:8 row_mask:0xf bank_mask:0xf
    v_cvt_pk_bf16_f32 v56, v96, v97
    v_cvt_pk_bf16_f32 v57, v98, v99
    v_cvt_pk_bf16_f32 v58, v100, v101
    v_cvt_pk_bf16_f32 v59, v102, v103
    v_lshlrev_b32 v96, 16, v56
    v_and_b32 v97, 0xffff0000, v56
    v_lshlrev_b32 v98, 16, v57
    v_and_b32 v99, 0xffff0000, v57
    v_lshlrev_b32 v100, 16, v58
    v_and_b32 v101, 0xffff0000, v58
    v_lshlrev_b32 v102, 16, v59
    v_and_b32 v103, 0xffff0000, v59
    v_mul_f32 v96, s83, v96
    v_mul_f32 v97, s83, v97
    v_mul_f32 v98, s83, v98
    v_mul_f32 v99, s83, v99
    v_mul_f32 v100, s83, v100
    v_mul_f32 v101, s83, v101
    v_mul_f32 v102, s83, v102
    v_mul_f32 v103, s83, v103
    v_cvt_pk_bf16_f32 v56, v96, v97
    v_cvt_pk_bf16_f32 v57, v98, v99
    v_cvt_pk_bf16_f32 v58, v100, v101
    v_cvt_pk_bf16_f32 v59, v102, v103
    v_lshlrev_b32 v96, 16, v56
    v_and_b32 v97, 0xffff0000, v56
    v_lshlrev_b32 v98, 16, v57
    v_and_b32 v99, 0xffff0000, v57
    v_lshlrev_b32 v100, 16, v58
    v_and_b32 v101, 0xffff0000, v58
    v_lshlrev_b32 v102, 16, v59
    v_and_b32 v103, 0xffff0000, v59
    v_max3_f32 v11, v11, v96, v97
    v_max3_f32 v11, v11, v98, v99
    v_max3_f32 v11, v11, v100, v101
    v_max3_f32 v11, v11, v102, v103
    v_mfma_f32_16x16x32_bf16 v[24:27], a[192:195], v[16:19], 0
    v_mfma_f32_16x16x32_bf16 v[28:31], a[200:203], v[16:19], 0
    v_mfma_f32_16x16x32_bf16 v[32:35], a[208:211], v[16:19], 0
    v_mfma_f32_16x16x32_bf16 v[36:39], a[216:219], v[16:19], 0
    v_mfma_f32_16x16x32_bf16 v[24:27], a[196:199], v[20:23], v[24:27]
    v_mfma_f32_16x16x32_bf16 v[28:31], a[204:207], v[20:23], v[28:31]
    v_mfma_f32_16x16x32_bf16 v[32:35], a[212:215], v[20:23], v[32:35]
    v_mfma_f32_16x16x32_bf16 v[36:39], a[220:223], v[20:23], v[36:39]
    v_add_f32_dpp v104, v41, v40 row_ror:8 row_mask:0xf bank_mask:0xf
    v_add_f32_dpp v105, v43, v42 row_ror:8 row_mask:0xf bank_mask:0xf
    v_add_f32_dpp v106, v45, v44 row_ror:8 row_mask:0xf bank_mask:0xf
    v_add_f32_dpp v107, v47, v46 row_ror:8 row_mask:0xf bank_mask:0xf
    v_add_f32_dpp v108, v49, v48 row_ror:8 row_mask:0xf bank_mask:0xf
    v_add_f32_dpp v109, v51, v50 row_ror:8 row_mask:0xf bank_mask:0xf
    v_add_f32_dpp v110, v53, v52 row_ror:8 row_mask:0xf bank_mask:0xf
    v_add_f32_dpp v111, v55, v54 row_ror:8 row_mask:0xf bank_mask:0xf
    v_cvt_pk_bf16_f32 v56, v104, v105
    v_cvt_pk_bf16_f32 v57, v106, v107
    v_cvt_pk_bf16_f32 v58, v108, v109
    v_cvt_pk_bf16_f32 v59, v110, v111
    v_lshlrev_b32 v104, 16, v56
    v_and_b32 v105, 0xffff0000, v56
    v_lshlrev_b32 v106, 16, v57
    v_and_b32 v107, 0xffff0000, v57
    v_lshlrev_b32 v108, 16, v58
    v_and_b32 v109, 0xffff0000, v58
    v_lshlrev_b32 v110, 16, v59
    v_and_b32 v111, 0xffff0000, v59
    v_mul_f32 v104, s83, v104
    v_mul_f32 v105, s83, v105
    v_mul_f32 v106, s83, v106
    v_mul_f32 v107, s83, v107
    v_mul_f32 v108, s83, v108
    v_mul_f32 v109, s83, v109
    v_mul_f32 v110, s83, v110
    v_mul_f32 v111, s83, v111
    v_cvt_pk_bf16_f32 v56, v104, v105
    v_cvt_pk_bf16_f32 v57, v106, v107
    v_cvt_pk_bf16_f32 v58, v108, v109
    v_cvt_pk_bf16_f32 v59, v110, v111
    v_lshlrev_b32 v104, 16, v56
    v_and_b32 v105, 0xffff0000, v56
    v_lshlrev_b32 v106, 16, v57
    v_and_b32 v107, 0xffff0000, v57
    v_lshlrev_b32 v108, 16, v58
    v_and_b32 v109, 0xffff0000, v58
    v_lshlrev_b32 v110, 16, v59
    v_and_b32 v111, 0xffff0000, v59
    v_max3_f32 v11, v11, v104, v105
    v_max3_f32 v11, v11, v106, v107
    v_max3_f32 v11, v11, v108, v109
    v_max3_f32 v11, v11, v110, v111
    v_mfma_f32_16x16x32_bf16 v[40:43], a[224:227], v[16:19], 0
    v_mfma_f32_16x16x32_bf16 v[44:47], a[232:235], v[16:19], 0
    v_mfma_f32_16x16x32_bf16 v[48:51], a[240:243], v[16:19], 0
    v_mfma_f32_16x16x32_bf16 v[52:55], a[248:251], v[16:19], 0
    v_mfma_f32_16x16x32_bf16 v[40:43], a[228:231], v[20:23], v[40:43]
    v_mfma_f32_16x16x32_bf16 v[44:47], a[236:239], v[20:23], v[44:47]
    v_mfma_f32_16x16x32_bf16 v[48:51], a[244:247], v[20:23], v[48:51]
    v_mfma_f32_16x16x32_bf16 v[52:55], a[252:255], v[20:23], v[52:55]
    v_add_f32_dpp v112, v25, v24 row_ror:8 row_mask:0xf bank_mask:0xf
    v_add_f32_dpp v113, v27, v26 row_ror:8 row_mask:0xf bank_mask:0xf
    v_add_f32_dpp v114, v29, v28 row_ror:8 row_mask:0xf bank_mask:0xf
    v_add_f32_dpp v115, v31, v30 row_ror:8 row_mask:0xf bank_mask:0xf
    v_add_f32_dpp v116, v33, v32 row_ror:8 row_mask:0xf bank_mask:0xf
    v_add_f32_dpp v117, v35, v34 row_ror:8 row_mask:0xf bank_mask:0xf
    v_add_f32_dpp v118, v37, v36 row_ror:8 row_mask:0xf bank_mask:0xf
    v_add_f32_dpp v119, v39, v38 row_ror:8 row_mask:0xf bank_mask:0xf
    v_cvt_pk_bf16_f32 v56, v112, v113
    v_cvt_pk_bf16_f32 v57, v114, v115
    v_cvt_pk_bf16_f32 v58, v116, v117
    v_cvt_pk_bf16_f32 v59, v118, v119
    v_lshlrev_b32 v112, 16, v56
    v_and_b32 v113, 0xffff0000, v56
    v_lshlrev_b32 v114, 16, v57
    v_and_b32 v115, 0xffff0000, v57
    v_lshlrev_b32 v116, 16, v58
    v_and_b32 v117, 0xffff0000, v58
    v_lshlrev_b32 v118, 16, v59
    v_and_b32 v119, 0xffff0000, v59
    v_mul_f32 v112, s83, v112
    v_mul_f32 v113, s83, v113
    v_mul_f32 v114, s83, v114
    v_mul_f32 v115, s83, v115
    v_mul_f32 v116, s83, v116
    v_mul_f32 v117, s83, v117
    v_mul_f32 v118, s83, v118
    v_mul_f32 v119, s83, v119
    v_cvt_pk_bf16_f32 v56, v112, v113
    v_cvt_pk_bf16_f32 v57, v114, v115
    v_cvt_pk_bf16_f32 v58, v116, v117
    v_cvt_pk_bf16_f32 v59, v118, v119
    v_lshlrev_b32 v112, 16, v56
    v_and_b32 v113, 0xffff0000, v56
    v_lshlrev_b32 v114, 16, v57
    v_and_b32 v115, 0xffff0000, v57
    v_lshlrev_b32 v116, 16, v58
    v_and_b32 v117, 0xffff0000, v58
    v_lshlrev_b32 v118, 16, v59
    v_and_b32 v119, 0xffff0000, v59
    v_max3_f32 v11, v11, v112, v113
    v_max3_f32 v11, v11, v114, v115
    v_max3_f32 v11, v11, v116, v117
    v_max3_f32 v11, v11, v118, v119
    v_add_f32_dpp v120, v41, v40 row_ror:8 row_mask:0xf bank_mask:0xf
    v_add_f32_dpp v121, v43, v42 row_ror:8 row_mask:0xf bank_mask:0xf
    v_add_f32_dpp v122, v45, v44 row_ror:8 row_mask:0xf bank_mask:0xf
    v_add_f32_dpp v123, v47, v46 row_ror:8 row_mask:0xf bank_mask:0xf
    v_add_f32_dpp v124, v49, v48 row_ror:8 row_mask:0xf bank_mask:0xf
    v_add_f32_dpp v125, v51, v50 row_ror:8 row_mask:0xf bank_mask:0xf
    v_add_f32_dpp v126, v53, v52 row_ror:8 row_mask:0xf bank_mask:0xf
    v_add_f32_dpp v127, v55, v54 row_ror:8 row_mask:0xf bank_mask:0xf
    v_cvt_pk_bf16_f32 v56, v120, v121
    v_cvt_pk_bf16_f32 v57, v122, v123
    v_cvt_pk_bf16_f32 v58, v124, v125
    v_cvt_pk_bf16_f32 v59, v126, v127
    v_lshlrev_b32 v120, 16, v56
    v_and_b32 v121, 0xffff0000, v56
    v_lshlrev_b32 v122, 16, v57
    v_and_b32 v123, 0xffff0000, v57
    v_lshlrev_b32 v124, 16, v58
    v_and_b32 v125, 0xffff0000, v58
    v_lshlrev_b32 v126, 16, v59
    v_and_b32 v127, 0xffff0000, v59
    v_mul_f32 v120, s83, v120
    v_mul_f32 v121, s83, v121
    v_mul_f32 v122, s83, v122
    v_mul_f32 v123, s83, v123
    v_mul_f32 v124, s83, v124
    v_mul_f32 v125, s83, v125
    v_mul_f32 v126, s83, v126
    v_mul_f32 v127, s83, v127
    v_cvt_pk_bf16_f32 v56, v120, v121
    v_cvt_pk_bf16_f32 v57, v122, v123
    v_cvt_pk_bf16_f32 v58, v124, v125
    v_cvt_pk_bf16_f32 v59, v126, v127
    v_lshlrev_b32 v120, 16, v56
    v_and_b32 v121, 0xffff0000, v56
    v_lshlrev_b32 v122, 16, v57
    v_and_b32 v123, 0xffff0000, v57
    v_lshlrev_b32 v124, 16, v58
    v_and_b32 v125, 0xffff0000, v58
    v_lshlrev_b32 v126, 16, v59
    v_and_b32 v127, 0xffff0000, v59
    v_max3_f32 v11, v11, v120, v121
    v_max3_f32 v11, v11, v122, v123
    v_max3_f32 v11, v11, v124, v125
    v_max3_f32 v11, v11, v126, v127
    v_mov_b32 v61, v11
    s_waitcnt vmcnt(11)
    s_add_u32 s26, s38, 4
    s_and_b32 s26, s26, 15
    s_lshl_b32 s26, s26, 18
    buffer_load_dwordx4 v[192:195], v3, s[48:51], s26 offen offset:0 nt
    v_permlane16_swap_b32 v11, v61
    v_max_f32 v11, v11, v61
    v_mov_b32 v61, v11
    s_nop 1
    v_permlane32_swap_b32 v11, v61
    v_max_f32 v11, v11, v61
    v_mul_f32 v61, s84, v11
    v_mov_b32 v12, 0
    v_mov_b32 v62, 0
    v_fma_f32 v64, v64, s84, -v61
    v_fma_f32 v65, v65, s84, -v61
    v_fma_f32 v66, v66, s84, -v61
    v_fma_f32 v67, v67, s84, -v61
    v_fma_f32 v68, v68, s84, -v61
    v_fma_f32 v69, v69, s84, -v61
    v_fma_f32 v70, v70, s84, -v61
    v_fma_f32 v71, v71, s84, -v61
    v_exp_f32 v64, v64
    v_exp_f32 v65, v65
    v_exp_f32 v66, v66
    v_exp_f32 v67, v67
    v_exp_f32 v68, v68
    v_exp_f32 v69, v69
    v_exp_f32 v70, v70
    v_exp_f32 v71, v71
    v_add_f32 v12, v12, v64
    v_add_f32 v62, v62, v65
    v_add_f32 v12, v12, v66
    v_add_f32 v62, v62, v67
    v_add_f32 v12, v12, v68
    v_add_f32 v62, v62, v69
    s_waitcnt vmcnt(11)
    buffer_load_dwordx4 v[196:199], v3, s[48:51], s26 offen offset:1024 nt
    v_add_f32 v12, v12, v70
    v_add_f32 v62, v62, v71
    v_cvt_pk_bf16_f32 v64, v64, v65
    v_cvt_pk_bf16_f32 v65, v66, v67
    v_cvt_pk_bf16_f32 v66, v68, v69
    v_cvt_pk_bf16_f32 v67, v70, v71
    v_fma_f32 v72, v72, s84, -v61
    v_fma_f32 v73, v73, s84, -v61
    v_fma_f32 v74, v74, s84, -v61
    v_fma_f32 v75, v75, s84, -v61
    v_fma_f32 v76, v76, s84, -v61
    v_fma_f32 v77, v77, s84, -v61
    v_fma_f32 v78, v78, s84, -v61
    v_fma_f32 v79, v79, s84, -v61
    v_exp_f32 v72, v72
    v_exp_f32 v73, v73
    v_exp_f32 v74, v74
    v_exp_f32 v75, v75
    v_exp_f32 v76, v76
    v_exp_f32 v77, v77
    v_exp_f32 v78, v78
    v_exp_f32 v79, v79
    v_add_f32 v12, v12, v72
    v_add_f32 v62, v62, v73
    v_add_f32 v12, v12, v74
    v_add_f32 v62, v62, v75
    v_add_f32 v12, v12, v76
    v_add_f32 v62, v62, v77
    v_add_f32 v12, v12, v78
    v_add_f32 v62, v62, v79
    s_waitcnt vmcnt(11)
    buffer_load_dwordx4 v[200:203], v3, s[48:51], s26 offen offset:2048 nt
    v_cvt_pk_bf16_f32 v72, v72, v73
    v_cvt_pk_bf16_f32 v73, v74, v75
    v_cvt_pk_bf16_f32 v74, v76, v77
    v_cvt_pk_bf16_f32 v75, v78, v79
    v_fma_f32 v80, v80, s84, -v61
    v_fma_f32 v81, v81, s84, -v61
    v_fma_f32 v82, v82, s84, -v61
    v_fma_f32 v83, v83, s84, -v61
    v_fma_f32 v84, v84, s84, -v61
    v_fma_f32 v85, v85, s84, -v61
    v_fma_f32 v86, v86, s84, -v61
    v_fma_f32 v87, v87, s84, -v61
    v_exp_f32 v80, v80
    v_exp_f32 v81, v81
    v_exp_f32 v82, v82
    v_exp_f32 v83, v83
    v_exp_f32 v84, v84
    v_exp_f32 v85, v85
    v_exp_f32 v86, v86
    v_exp_f32 v87, v87
    v_add_f32 v12, v12, v80
    v_add_f32 v62, v62, v81
    v_add_f32 v12, v12, v82
    v_add_f32 v62, v62, v83
    v_add_f32 v12, v12, v84
    v_add_f32 v62, v62, v85
    v_add_f32 v12, v12, v86
    v_add_f32 v62, v62, v87
    v_cvt_pk_bf16_f32 v80, v80, v81
    v_cvt_pk_bf16_f32 v81, v82, v83
    s_waitcnt vmcnt(11)
    buffer_load_dwordx4 v[204:207], v3, s[48:51], s26 offen offset:3072 nt
    v_cvt_pk_bf16_f32 v82, v84, v85
    v_cvt_pk_bf16_f32 v83, v86, v87
    v_fma_f32 v88, v88, s84, -v61
    v_fma_f32 v89, v89, s84, -v61
    v_fma_f32 v90, v90, s84, -v61
    v_fma_f32 v91, v91, s84, -v61
    v_fma_f32 v92, v92, s84, -v61
    v_fma_f32 v93, v93, s84, -v61
    v_fma_f32 v94, v94, s84, -v61
    v_fma_f32 v95, v95, s84, -v61
    v_exp_f32 v88, v88
    v_exp_f32 v89, v89
    v_exp_f32 v90, v90
    v_exp_f32 v91, v91
    v_exp_f32 v92, v92
    v_exp_f32 v93, v93
    v_exp_f32 v94, v94
    v_exp_f32 v95, v95
    v_add_f32 v12, v12, v88
    v_add_f32 v62, v62, v89
    v_add_f32 v12, v12, v90
    v_add_f32 v62, v62, v91
    v_add_f32 v12, v12, v92
    v_add_f32 v62, v62, v93
    v_add_f32 v12, v12, v94
    v_add_f32 v62, v62, v95
    v_cvt_pk_bf16_f32 v88, v88, v89
    v_cvt_pk_bf16_f32 v89, v90, v91
    v_cvt_pk_bf16_f32 v90, v92, v93
    v_cvt_pk_bf16_f32 v91, v94, v95
    s_waitcnt vmcnt(11)
    s_add_u32 s26, s38, 5
    s_and_b32 s26, s26, 15
    s_lshl_b32 s26, s26, 18
    buffer_load_dwordx4 v[208:211], v3, s[48:51], s26 offen offset:0 nt
    v_fma_f32 v96, v96, s84, -v61
    v_fma_f32 v97, v97, s84, -v61
    v_fma_f32 v98, v98, s84, -v61
    v_fma_f32 v99, v99, s84, -v61
    v_fma_f32 v100, v100, s84, -v61
    v_fma_f32 v101, v101, s84, -v61
    v_fma_f32 v102, v102, s84, -v61
    v_fma_f32 v103, v103, s84, -v61
    v_exp_f32 v96, v96
    v_exp_f32 v97, v97
    v_exp_f32 v98, v98
    v_exp_f32 v99, v99
    v_exp_f32 v100, v100
    v_exp_f32 v101, v101
    v_exp_f32 v102, v102
    v_exp_f32 v103, v103
    v_add_f32 v12, v12, v96
    v_add_f32 v62, v62, v97
    v_add_f32 v12, v12, v98
    v_add_f32 v62, v62, v99
    v_add_f32 v12, v12, v100
    v_add_f32 v62, v62, v101
    v_add_f32 v12, v12, v102
    v_add_f32 v62, v62, v103
    v_cvt_pk_bf16_f32 v96, v96, v97
    v_cvt_pk_bf16_f32 v97, v98, v99
    v_cvt_pk_bf16_f32 v98, v100, v101
    v_cvt_pk_bf16_f32 v99, v102, v103
    v_fma_f32 v104, v104, s84, -v61
    v_fma_f32 v105, v105, s84, -v61
    s_waitcnt vmcnt(11)
    buffer_load_dwordx4 v[212:215], v3, s[48:51], s26 offen offset:1024 nt
    v_fma_f32 v106, v106, s84, -v61
    v_fma_f32 v107, v107, s84, -v61
    v_fma_f32 v108, v108, s84, -v61
    v_fma_f32 v109, v109, s84, -v61
    v_fma_f32 v110, v110, s84, -v61
    v_fma_f32 v111, v111, s84, -v61
    v_exp_f32 v104, v104
    v_exp_f32 v105, v105
    v_exp_f32 v106, v106
    v_exp_f32 v107, v107
    v_exp_f32 v108, v108
    v_exp_f32 v109, v109
    v_exp_f32 v110, v110
    v_exp_f32 v111, v111
    v_add_f32 v12, v12, v104
    v_add_f32 v62, v62, v105
    v_add_f32 v12, v12, v106
    v_add_f32 v62, v62, v107
    v_add_f32 v12, v12, v108
    v_add_f32 v62, v62, v109
    v_add_f32 v12, v12, v110
    v_add_f32 v62, v62, v111
    v_cvt_pk_bf16_f32 v104, v104, v105
    v_cvt_pk_bf16_f32 v105, v106, v107
    v_cvt_pk_bf16_f32 v106, v108, v109
    v_cvt_pk_bf16_f32 v107, v110, v111
    v_fma_f32 v112, v112, s84, -v61
    v_fma_f32 v113, v113, s84, -v61
    v_fma_f32 v114, v114, s84, -v61
    v_fma_f32 v115, v115, s84, -v61
    s_waitcnt vmcnt(11)
    buffer_load_dwordx4 v[216:219], v3, s[48:51], s26 offen offset:2048 nt
    v_fma_f32 v116, v116, s84, -v61
    v_fma_f32 v117, v117, s84, -v61
    v_fma_f32 v118, v118, s84, -v61
    v_fma_f32 v119, v119, s84, -v61
    v_exp_f32 v112, v112
    v_exp_f32 v113, v113
    v_exp_f32 v114, v114
    v_exp_f32 v115, v115
    v_exp_f32 v116, v116
    v_exp_f32 v117, v117
    v_exp_f32 v118, v118
    v_exp_f32 v119, v119
    v_add_f32 v12, v12, v112
    v_add_f32 v62, v62, v113
    v_add_f32 v12, v12, v114
    v_add_f32 v62, v62, v115
    v_add_f32 v12, v12, v116
    v_add_f32 v62, v62, v117
    v_add_f32 v12, v12, v118
    v_add_f32 v62, v62, v119
    v_cvt_pk_bf16_f32 v112, v112, v113
    v_cvt_pk_bf16_f32 v113, v114, v115
    v_cvt_pk_bf16_f32 v114, v116, v117
    v_cvt_pk_bf16_f32 v115, v118, v119
    v_fma_f32 v120, v120, s84, -v61
    v_fma_f32 v121, v121, s84, -v61
    v_fma_f32 v122, v122, s84, -v61
    v_fma_f32 v123, v123, s84, -v61
    v_fma_f32 v124, v124, s84, -v61
    v_fma_f32 v125, v125, s84, -v61
    s_waitcnt vmcnt(11)
    buffer_load_dwordx4 v[220:223], v3, s[48:51], s26 offen offset:3072 nt
    v_fma_f32 v126, v126, s84, -v61
    v_fma_f32 v127, v127, s84, -v61
    v_exp_f32 v120, v120
    v_exp_f32 v121, v121
    v_exp_f32 v122, v122
    v_exp_f32 v123, v123
    v_exp_f32 v124, v124
    v_exp_f32 v125, v125
    v_exp_f32 v126, v126
    v_exp_f32 v127, v127
    v_add_f32 v12, v12, v120
    v_add_f32 v62, v62, v121
    v_add_f32 v12, v12, v122
    v_add_f32 v62, v62, v123
    v_add_f32 v12, v12, v124
    v_add_f32 v62, v62, v125
    v_add_f32 v12, v12, v126
    v_add_f32 v62, v62, v127
    v_cvt_pk_bf16_f32 v120, v120, v121
    v_cvt_pk_bf16_f32 v121, v122, v123
    v_cvt_pk_bf16_f32 v122, v124, v125
    v_cvt_pk_bf16_f32 v123, v126, v127
    v_add_f32 v12, v12, v62
    v_mov_b32 v62, v12
    s_nop 1
    v_permlane16_swap_b32 v12, v62
    v_add_f32 v12, v12, v62
    v_mov_b32 v62, v12
    s_nop 1
    v_permlane32_swap_b32 v12, v62
    v_add_f32 v12, v12, v62
    s_lshl_b32 s72, s74, 2
    s_add_u32 s72, s72, s75
    s_lshl_b32 s86, s72, 13
    s_add_u32 s86, s86, 3145728
    s_lshl_b32 s72, s76, 9
    s_lshl_b32 s73, s3, 7
    s_add_u32 s72, s72, s73
    s_add_u32 s72, s72, s86
    s_lshl_b32 s73, s3, 11
    s_add_u32 s86, s86, s73
    v_mov_b32 v24, v11
    v_mov_b32 v25, v5
    v_mov_b32 v26, v12
    v_mov_b32 v27, v5
    s_mov_b64 exec, 0xff
    s_cmp_eq_u32 s80, 0
    s_cbranch_scc1 L_pl_ml
    buffer_store_dwordx4 v[24:27], v4, s[68:71], s72 offen sc1
    s_branch L_pd_ml
L_pl_ml:
    buffer_store_dwordx4 v[24:27], v4, s[68:71], s72 offen
L_pd_ml:
    s_mov_b64 exec, -1
    v_lshrrev_b32 v13, 7, v6
    v_and_b32 v14, 3, v13
    v_bfe_u32 v15, v13, 3, 1
    v_lshl_or_b32 v14, v15, 2, v14
    s_lshl_b32 s72, s3, 1
    v_xor_b32 v14, s72, v14
    v_and_b32 v15, 0x18, v6
    v_lshl_add_u32 v15, v14, 5, v15
    v_lshl_add_u32 v21, v13, 8, v15
    v_add_u32 v21, 65536, v21
    v_xor_b32 v20, 32, v21
    v_and_b32 v15, 3, v1
    v_mul_u32_u24 v15, 272, v15
    v_add_u32 v22, v15, v10
    v_add_u32 v22, 149760, v22
    v_and_b32 v15, 7, v1
    v_mul_u32_u24 v56, 528, v15
    v_lshl_add_u32 v56, v10, 3, v56
    s_mul_i32 s72, s3, 4224
    v_add_u32 v56, s72, v56
    v_bfe_u32 v15, v1, 3, 1
    v_lshl_add_u32 v56, v15, 15, v56
    v_lshrrev_b32 v15, 5, v0
    v_mul_u32_u24 v57, 528, v15
    v_lshlrev_b32 v23, 4, v15
    v_add_u32 v23, 149504, v23
    v_lshlrev_b32 v58, 14, v15
    v_and_b32 v15, 31, v0
    v_lshl_add_u32 v57, v15, 4, v57
    v_lshl_add_u32 v58, v15, 3, v58
    v_and_b32 v12, 0x70, v4
    v_add_u32 v12, 147456, v12
    s_lshl_b32 s72, s3, 2
    v_add_u32 v63, s72, v12
    v_bfe_u32 v15, v1, 3, 2
    v_lshlrev_b32 v59, 6, v15
    v_and_b32 v15, 7, v1
    v_lshl_add_u32 v59, v15, 1, v59
    s_mul_i32 s72, s3, 272
    s_add_u32 s72, s72, 149760
    v_add_u32 v59, s72, v59
    v_bfe_u32 v15, v1, 3, 2
    v_and_b32 v7, 0x70, v4
    v_lshl_add_u32 v7, v15, 12, v7
    v_lshrrev_b32 v15, 5, v1
    v_lshl_add_u32 v7, v15, 19, v7
    v_and_b32 v18, 3, v1
    v_lshlrev_b32 v18, 1, v18
    s_lshl_b32 s72, s79, 3
    s_add_u32 s72, s72, s87
    v_add_u32 v18, s72, v18
    v_bfe_u32 v15, v1, 2, 2
    v_lshl_add_u32 v19, v15, 11, v18
    v_bfe_u32 v15, v1, 2, 3
    v_and_b32 v17, 0x30, v4
    v_lshl_add_u32 v17, v15, 7, v17
    v_lshrrev_b32 v15, 5, v1
    v_lshl_add_u32 v17, v15, 19, v17
    s_lshl_b32 s72, s75, 17
    s_lshl_b32 s73, s74, 12
    s_add_u32 s72, s72, s73
    s_lshl_b32 s73, s76, 8
    s_add_u32 s72, s72, s73
    s_add_u32 s42, s72, 2097152
    s_lshl_b32 s72, s79, 14
    s_lshl_b32 s73, s3, 12
    s_add_u32 s72, s72, s73
    s_add_u32 s43, s72, 2097152
    s_lshl_b32 s85, s87, 8
    s_lshl_b32 s72, s3, 14
    s_add_u32 s85, s85, s72
    s_lshl_b32 s72, s79, 7
    s_add_u32 s85, s85, s72
    s_add_u32 s85, s85, 4194304
    v_and_b32 v15, 31, v1
    s_lshl_b32 s72, s79, 2
    s_add_u32 s72, s72, s3
    s_lshl_b32 s72, s72, 8
    s_add_u32 s72, s72, 1835008
    v_lshlrev_b32 v15, 3, v15
    v_add_u32 v2, s72, v15
    v_perm_b32 v24, v132, v128, s81
    v_perm_b32 v25, v140, v136, s81
    v_perm_b32 v26, v148, v144, s81
    v_perm_b32 v27, v156, v152, s81
    v_perm_b32 v28, v132, v128, s82
    v_perm_b32 v29, v140, v136, s82
    v_perm_b32 v30, v148, v144, s82
    v_perm_b32 v31, v156, v152, s82
    v_mfma_f32_16x16x32_bf16 a[0:3], v[24:27], v[64:67], 0
    v_perm_b32 v32, v133, v129, s81
    v_perm_b32 v33, v141, v137, s81
    v_perm_b32 v34, v149, v145, s81
    v_perm_b32 v35, v157, v153, s81
    v_mfma_f32_16x16x32_bf16 a[4:7], v[28:31], v[64:67], 0
    v_perm_b32 v36, v133, v129, s82
    v_perm_b32 v37, v141, v137, s82
    v_perm_b32 v38, v149, v145, s82
    v_perm_b32 v39, v157, v153, s82
    v_mfma_f32_16x16x32_bf16 a[8:11], v[32:35], v[64:67], 0
    v_perm_b32 v40, v134, v130, s81
    v_perm_b32 v41, v142, v138, s81
    v_perm_b32 v42, v150, v146, s81
    v_perm_b32 v43, v158, v154, s81
    v_mfma_f32_16x16x32_bf16 a[12:15], v[36:39], v[64:67], 0
    v_perm_b32 v44, v134, v130, s82
    v_perm_b32 v45, v142, v138, s82
    v_perm_b32 v46, v150, v146, s82
    v_perm_b32 v47, v158, v154, s82
    v_mfma_f32_16x16x32_bf16 a[16:19], v[40:43], v[64:67], 0
    v_perm_b32 v48, v135, v131, s81
    v_perm_b32 v49, v143, v139, s81
    v_perm_b32 v50, v151, v147, s81
    v_perm_b32 v51, v159, v155, s81
    v_mfma_f32_16x16x32_bf16 a[20:23], v[44:47], v[64:67], 0
    v_perm_b32 v52, v135, v131, s82
    v_perm_b32 v53, v143, v139, s82
    v_perm_b32 v54, v151, v147, s82
    v_perm_b32 v55, v159, v155, s82
    v_mfma_f32_16x16x32_bf16 a[24:27], v[48:51], v[64:67], 0
    s_nop 0
    v_mfma_f32_16x16x32_bf16 a[28:31], v[52:55], v[64:67], 0
    v_bfe_u32 v100, v5, 0, 8
    v_bfe_u32 v101, v5, 8, 8
    v_bfe_u32 v102, v5, 16, 8
    v_bfe_u32 v103, v5, 24, 8
    v_and_b32 v13, 15, v1
    v_lshrrev_b32 v14, 3, v13
    v_lshlrev_b32 v65, 3, v13
    v_sub_u32 v13, v13, v14
    v_min_u32 v13, 13, v13
    s_lshr_b32 s72, s87, 3
    s_add_u32 s72, s72, s79
    s_lshl_b32 s73, s72, 7
    v_add_u32 v65, s73, v65
    s_mul_i32 s72, s72, 14
    v_add_u32 v13, s72, v13
    v_lshlrev_b32 v64, 4, v13
    v_lshl_add_u32 v64, v10, 12, v64
    v_add_u32 v64, 1572864, v64
    v_lshlrev_b32 v66, 1, v13
    s_waitcnt vmcnt(9)
    v_perm_b32 v24, v164, v160, s81
    s_cmp_lg_u32 s3, 0
    s_cbranch_scc1 L_w0_hl
    global_load_short_d16_hi v66, v66, s[30:31]
    buffer_load_dwordx4 v[108:111], v64, s[68:71], 0 offen sc1
L_w0_hl:
    v_perm_b32 v25, v172, v168, s81
    v_perm_b32 v26, v180, v176, s81
    v_perm_b32 v27, v188, v184, s81
    v_perm_b32 v28, v164, v160, s82
    v_perm_b32 v29, v172, v168, s82
    s_add_u32 s26, s38, 6
    s_and_b32 s26, s26, 15
    s_lshl_b32 s26, s26, 18
    buffer_load_dwordx4 v[224:227], v3, s[48:51], s26 offen offset:0 nt
    v_perm_b32 v30, v180, v176, s82
    v_perm_b32 v31, v188, v184, s82
    v_mfma_f32_16x16x32_bf16 a[0:3], v[24:27], v[72:75], a[0:3]
    v_perm_b32 v32, v165, v161, s81
    v_perm_b32 v33, v173, v169, s81
    buffer_load_dwordx4 v[228:231], v3, s[48:51], s26 offen offset:1024 nt
    v_perm_b32 v34, v181, v177, s81
    v_perm_b32 v35, v189, v185, s81
    v_mfma_f32_16x16x32_bf16 a[4:7], v[28:31], v[72:75], a[4:7]
    v_perm_b32 v36, v165, v161, s82
    v_perm_b32 v37, v173, v169, s82
    buffer_load_dwordx4 v[232:235], v3, s[48:51], s26 offen offset:2048 nt
    v_perm_b32 v38, v181, v177, s82
    v_perm_b32 v39, v189, v185, s82
    v_mfma_f32_16x16x32_bf16 a[8:11], v[32:35], v[72:75], a[8:11]
    v_perm_b32 v40, v166, v162, s81
    v_perm_b32 v41, v174, v170, s81
    s_waitcnt vmcnt(6)
    buffer_load_dwordx4 v[236:239], v3, s[48:51], s26 offen offset:3072 nt
    v_perm_b32 v42, v182, v178, s81
    v_perm_b32 v43, v190, v186, s81
    v_mfma_f32_16x16x32_bf16 a[12:15], v[36:39], v[72:75], a[12:15]
    v_perm_b32 v44, v166, v162, s82
    v_perm_b32 v45, v174, v170, s82
    s_waitcnt vmcnt(6)
    s_add_u32 s26, s38, 7
    s_and_b32 s26, s26, 15
    s_lshl_b32 s26, s26, 18
    buffer_load_dwordx4 v[240:243], v3, s[48:51], s26 offen offset:0 nt
    v_perm_b32 v46, v182, v178, s82
    v_perm_b32 v47, v190, v186, s82
    v_mfma_f32_16x16x32_bf16 a[16:19], v[40:43], v[72:75], a[16:19]
    v_perm_b32 v48, v167, v163, s81
    v_perm_b32 v49, v175, v171, s81
    s_waitcnt vmcnt(6)
    buffer_load_dwordx4 v[244:247], v3, s[48:51], s26 offen offset:1024 nt
    v_perm_b32 v50, v183, v179, s81
    v_perm_b32 v51, v191, v187, s81
    v_mfma_f32_16x16x32_bf16 a[20:23], v[44:47], v[72:75], a[20:23]
    v_perm_b32 v52, v167, v163, s82
    v_perm_b32 v53, v175, v171, s82
    s_waitcnt vmcnt(6)
    buffer_load_dwordx4 v[248:251], v3, s[48:51], s26 offen offset:2048 nt
    v_perm_b32 v54, v183, v179, s82
    v_perm_b32 v55, v191, v187, s82
    v_mfma_f32_16x16x32_bf16 a[24:27], v[48:51], v[72:75], a[24:27]
    s_nop 0
    v_mfma_f32_16x16x32_bf16 a[28:31], v[52:55], v[72:75], a[28:31]
    s_waitcnt vmcnt(6)
    buffer_load_dwordx4 v[252:255], v3, s[48:51], s26 offen offset:3072 nt
    v_perm_b32 v24, v196, v192, s81
    s_waitcnt vmcnt(6)
    s_add_u32 s26, s38, 8
    s_and_b32 s26, s26, 15
    s_lshl_b32 s26, s26, 18
    buffer_load_dwordx4 v[128:131], v3, s[48:51], s26 offen offset:0 nt
    v_perm_b32 v25, v204, v200, s81
    v_perm_b32 v26, v212, v208, s81
    v_perm_b32 v27, v220, v216, s81
    v_perm_b32 v28, v196, v192, s82
    v_perm_b32 v29, v204, v200, s82
    s_waitcnt vmcnt(6)
    buffer_load_dwordx4 v[132:135], v3, s[48:51], s26 offen offset:1024 nt
    v_perm_b32 v30, v212, v208, s82
    v_perm_b32 v31, v220, v216, s82
    v_mfma_f32_16x16x32_bf16 a[0:3], v[24:27], v[80:83], a[0:3]
    v_perm_b32 v32, v197, v193, s81
    v_perm_b32 v33, v205, v201, s81
    s_waitcnt vmcnt(6)
    buffer_load_dwordx4 v[136:139], v3, s[48:51], s26 offen offset:2048 nt
    v_perm_b32 v34, v213, v209, s81
    v_perm_b32 v35, v221, v217, s81
    v_mfma_f32_16x16x32_bf16 a[4:7], v[28:31], v[80:83], a[4:7]
    v_perm_b32 v36, v197, v193, s82
    v_perm_b32 v37, v205, v201, s82
    s_waitcnt vmcnt(6)
    buffer_load_dwordx4 v[140:143], v3, s[48:51], s26 offen offset:3072 nt
    v_perm_b32 v38, v213, v209, s82
    v_perm_b32 v39, v221, v217, s82
    v_mfma_f32_16x16x32_bf16 a[8:11], v[32:35], v[80:83], a[8:11]
    v_perm_b32 v40, v198, v194, s81
    v_perm_b32 v41, v206, v202, s81
    s_waitcnt vmcnt(6)
    s_add_u32 s26, s38, 9
    s_and_b32 s26, s26, 15
    s_lshl_b32 s26, s26, 18
    buffer_load_dwordx4 v[144:147], v3, s[48:51], s26 offen offset:0 nt
    v_perm_b32 v42, v214, v210, s81
    v_perm_b32 v43, v222, v218, s81
    v_mfma_f32_16x16x32_bf16 a[12:15], v[36:39], v[80:83], a[12:15]
    v_perm_b32 v44, v198, v194, s82
    v_perm_b32 v45, v206, v202, s82
    s_waitcnt vmcnt(6)
    buffer_load_dwordx4 v[148:151], v3, s[48:51], s26 offen offset:1024 nt
    v_perm_b32 v46, v214, v210, s82
    v_perm_b32 v47, v222, v218, s82
    v_mfma_f32_16x16x32_bf16 a[16:19], v[40:43], v[80:83], a[16:19]
    v_perm_b32 v48, v199, v195, s81
    v_perm_b32 v49, v207, v203, s81
    s_waitcnt vmcnt(6)
    buffer_load_dwordx4 v[152:155], v3, s[48:51], s26 offen offset:2048 nt
    v_perm_b32 v50, v215, v211, s81
    v_perm_b32 v51, v223, v219, s81
    v_mfma_f32_16x16x32_bf16 a[20:23], v[44:47], v[80:83], a[20:23]
    v_perm_b32 v52, v199, v195, s82
    v_perm_b32 v53, v207, v203, s82
    s_waitcnt vmcnt(6)
    buffer_load_dwordx4 v[156:159], v3, s[48:51], s26 offen offset:3072 nt
    v_perm_b32 v54, v215, v211, s82
    v_perm_b32 v55, v223, v219, s82
    v_mfma_f32_16x16x32_bf16 a[24:27], v[48:51], v[80:83], a[24:27]
    s_nop 0
    v_mfma_f32_16x16x32_bf16 a[28:31], v[52:55], v[80:83], a[28:31]
    s_cmp_lg_u32 s3, 0
    s_cbranch_scc1 L_w0_h
    s_mov_b32 s88, 0
L_chk_h:
    v_xor_b32 v24, v108, v100
    v_xor_b32 v25, v109, v101
    v_xor_b32 v26, v110, v102
    v_xor_b32 v27, v111, v103
    v_or_b32 v13, v24, v25
    v_or_b32 v14, v26, v27
    v_or_b32 v13, v13, v14
    v_and_b32 v13, 0xff, v13
    v_cmp_ne_u32 vcc, 0, v13
    s_cbranch_vccz L_ok_h
    s_add_u32 s88, s88, 1
    s_cmp_gt_u32 s88, 262144
    s_cbranch_scc1 L_ok_h
    v_or3_b32 v13, v24, v25, v26
    v_or_b32 v13, v13, v27
    s_nop 1
    v_or_b32_dpp v13, v13, v13 quad_perm:[1,0,3,2] row_mask:0xf bank_mask:0xf
    s_nop 1
    v_or_b32_dpp v13, v13, v13 quad_perm:[2,3,0,1] row_mask:0xf bank_mask:0xf
    v_and_b32 v13, 0xff, v13
    v_cmp_ne_u32 vcc, 0, v13
    s_cbranch_vccz L_skip_h0
    s_mov_b64 exec, vcc
    buffer_load_dwordx4 v[108:111], v64, s[68:71], 0 offen sc1
    s_mov_b64 exec, -1
L_skip_h0:
    s_waitcnt vmcnt(0)
    s_branch L_chk_h
L_ok_h:
    v_mov_b32 v28, v24
    v_mov_b32 v29, v25
    v_mov_b32 v30, v26
    v_mov_b32 v31, v27
    v_permlane16_swap_b32 v24, v28
    v_permlane16_swap_b32 v25, v29
    v_permlane16_swap_b32 v26, v30
    v_permlane16_swap_b32 v27, v31
    v_add_f32 v24, v24, v28
    v_add_f32 v25, v25, v29
    v_add_f32 v26, v26, v30
    v_add_f32 v27, v27, v31
    v_mov_b32 v28, v24
    v_mov_b32 v29, v25
    v_mov_b32 v30, v26
    v_mov_b32 v31, v27
    v_permlane32_swap_b32 v24, v28
    v_permlane32_swap_b32 v25, v29
    v_permlane32_swap_b32 v26, v30
    v_permlane32_swap_b32 v27, v31
    v_add_f32 v24, v24, v28
    v_add_f32 v25, v25, v29
    v_add_f32 v26, v26, v30
    v_add_f32 v27, v27, v31
    v_and_b32 v66, 0xffff0000, v66
    v_cvt_pk_bf16_f32 v28, v24, v25
    v_cvt_pk_bf16_f32 v29, v26, v27
    v_lshlrev_b32 v24, 16, v28
    v_and_b32 v25, 0xffff0000, v28
    v_lshlrev_b32 v26, 16, v29
    v_and_b32 v27, 0xffff0000, v29
    v_add_f32 v24, v24, v66
    v_add_f32 v25, v25, v66
    v_add_f32 v26, v26, v66
    v_add_f32 v27, v27, v66
    v_cvt_pk_bf16_f32 v28, v24, v25
    v_cvt_pk_bf16_f32 v29, v26, v27
    v_lshlrev_b32 v24, 16, v28
    v_and_b32 v25, 0xffff0000, v28
    v_lshlrev_b32 v26, 16, v29
    v_and_b32 v27, 0xffff0000, v29
    v_mov_b32 v32, 0xc0135761
    s_mov_b32 s72, 0xbdd2d3e8
    v_mul_f32 v28, v24, v24
    v_mul_f32 v29, v25, v25
    v_mul_f32 v30, v26, v26
    v_mul_f32 v31, v27, v27
    v_fma_f32 v28, v28, s72, v32
    v_fma_f32 v29, v29, s72, v32
    v_fma_f32 v30, v30, s72, v32
    v_fma_f32 v31, v31, s72, v32
    v_mul_f32 v28, v24, v28
    v_mul_f32 v29, v25, v29
    v_mul_f32 v30, v26, v30
    v_mul_f32 v31, v27, v31
    v_exp_f32 v28, v28
    v_exp_f32 v29, v29
    v_exp_f32 v30, v30
    v_exp_f32 v31, v31
    v_add_f32 v28, 1.0, v28
    v_add_f32 v29, 1.0, v29
    v_add_f32 v30, 1.0, v30
    v_add_f32 v31, 1.0, v31
    v_rcp_f32 v28, v28
    v_rcp_f32 v29, v29
    v_rcp_f32 v30, v30
    v_rcp_f32 v31, v31
    v_mul_f32 v28, v24, v28
    v_mul_f32 v29, v25, v29
    v_mul_f32 v30, v26, v30
    v_mul_f32 v31, v27, v31
    v_cvt_pk_bf16_f32 v24, v28, v29
    v_cvt_pk_bf16_f32 v25, v30, v31
    s_mov_b64 exec, 0x8080
    v_mov_b32 v24, v5
    v_mov_b32 v25, v5
    s_mov_b32 s72, 1835008
    s_mov_b64 exec, 0xffff
    buffer_store_dwordx2 v[24:25], v65, s[68:71], s72 offen sc1
    s_mov_b64 exec, -1
L_w0_h:
    v_perm_b32 v24, v228, v224, s81
    buffer_load_dwordx4 v[68:71], v4, s[68:71], s86 offen offset:0 sc1
    v_perm_b32 v25, v236, v232, s81
    v_perm_b32 v26, v244, v240, s81
    v_perm_b32 v27, v252, v248, s81
    v_perm_b32 v28, v228, v224, s82
    v_perm_b32 v29, v236, v232, s82
    buffer_load_dwordx4 v[76:79], v4, s[68:71], s86 offen offset:1024 sc1
    v_perm_b32 v30, v244, v240, s82
    v_perm_b32 v31, v252, v248, s82
    v_mfma_f32_16x16x32_bf16 a[0:3], v[24:27], v[88:91], a[0:3]
    v_perm_b32 v32, v229, v225, s81
    v_perm_b32 v33, v237, v233, s81
    s_add_u32 s26, s38, 10
    s_and_b32 s26, s26, 15
    s_lshl_b32 s26, s26, 18
    buffer_load_dwordx4 v[160:163], v3, s[48:51], s26 offen offset:0 nt
    v_perm_b32 v34, v245, v241, s81
    v_perm_b32 v35, v253, v249, s81
    v_mfma_f32_16x16x32_bf16 a[4:7], v[28:31], v[88:91], a[4:7]
    v_perm_b32 v36, v229, v225, s82
    v_perm_b32 v37, v237, v233, s82
    buffer_load_dwordx4 v[164:167], v3, s[48:51], s26 offen offset:1024 nt
    v_perm_b32 v38, v245, v241, s82
    v_perm_b32 v39, v253, v249, s82
    v_mfma_f32_16x16x32_bf16 a[8:11], v[32:35], v[88:91], a[8:11]
    v_perm_b32 v40, v230, v226, s81
    v_perm_b32 v41, v238, v234, s81
    s_waitcnt vmcnt(6)
    buffer_load_dwordx4 v[168:171], v3, s[48:51], s26 offen offset:2048 nt
    v_perm_b32 v42, v246, v242, s81
    v_perm_b32 v43, v254, v250, s81
    v_mfma_f32_16x16x32_bf16 a[12:15], v[36:39], v[88:91], a[12:15]
    v_perm_b32 v44, v230, v226, s82
    v_perm_b32 v45, v238, v234, s82
    s_waitcnt vmcnt(6)
    buffer_load_dwordx4 v[172:175], v3, s[48:51], s26 offen offset:3072 nt
    v_perm_b32 v46, v246, v242, s82
    v_perm_b32 v47, v254, v250, s82
    v_mfma_f32_16x16x32_bf16 a[16:19], v[40:43], v[88:91], a[16:19]
    v_perm_b32 v48, v231, v227, s81
    v_perm_b32 v49, v239, v235, s81
    s_waitcnt vmcnt(6)
    s_add_u32 s26, s38, 11
    s_and_b32 s26, s26, 15
    s_lshl_b32 s26, s26, 18
    buffer_load_dwordx4 v[176:179], v3, s[48:51], s26 offen offset:0 nt
    v_perm_b32 v50, v247, v243, s81
    v_perm_b32 v51, v255, v251, s81
    v_mfma_f32_16x16x32_bf16 a[20:23], v[44:47], v[88:91], a[20:23]
    v_perm_b32 v52, v231, v227, s82
    v_perm_b32 v53, v239, v235, s82
    s_waitcnt vmcnt(6)
    buffer_load_dwordx4 v[180:183], v3, s[48:51], s26 offen offset:1024 nt
    v_perm_b32 v54, v247, v243, s82
    v_perm_b32 v55, v255, v251, s82
    v_mfma_f32_16x16x32_bf16 a[24:27], v[48:51], v[88:91], a[24:27]
    s_nop 0
    v_mfma_f32_16x16x32_bf16 a[28:31], v[52:55], v[88:91], a[28:31]
    s_waitcnt vmcnt(6)
    buffer_load_dwordx4 v[184:187], v3, s[48:51], s26 offen offset:2048 nt
    s_waitcnt vmcnt(6)
    buffer_load_dwordx4 v[188:191], v3, s[48:51], s26 offen offset:3072 nt
    v_perm_b32 v24, v132, v128, s81
    s_waitcnt vmcnt(6)
    s_add_u32 s26, s38, 12
    s_and_b32 s26, s26, 15
    s_lshl_b32 s26, s26, 18
    buffer_load_dwordx4 v[192:195], v3, s[48:51], s26 offen offset:0 nt
    v_perm_b32 v25, v140, v136, s81
    v_perm_b32 v26, v148, v144, s81
    v_perm_b32 v27, v156, v152, s81
    v_perm_b32 v28, v132, v128, s82
    v_perm_b32 v29, v140, v136, s82
    s_waitcnt vmcnt(6)
    buffer_load_dwordx4 v[196:199], v3, s[48:51], s26 offen offset:1024 nt
    v_perm_b32 v30, v148, v144, s82
    v_perm_b32 v31, v156, v152, s82
    v_mfma_f32_16x16x32_bf16 a[0:3], v[24:27], v[96:99], a[0:3]
    v_perm_b32 v32, v133, v129, s81
    v_perm_b32 v33, v141, v137, s81
    s_waitcnt vmcnt(6)
    buffer_load_dwordx4 v[200:203], v3, s[48:51], s26 offen offset:2048 nt
    v_perm_b32 v34, v149, v145, s81
    v_perm_b32 v35, v157, v153, s81
    v_mfma_f32_16x16x32_bf16 a[4:7], v[28:31], v[96:99], a[4:7]
    v_perm_b32 v36, v133, v129, s82
    v_perm_b32 v37, v141, v137, s82
    s_waitcnt vmcnt(6)
    buffer_load_dwordx4 v[204:207], v3, s[48:51], s26 offen offset:3072 nt
    v_perm_b32 v38, v149, v145, s82
    v_perm_b32 v39, v157, v153, s82
    v_mfma_f32_16x16x32_bf16 a[8:11], v[32:35], v[96:99], a[8:11]
    v_perm_b32 v40, v134, v130, s81
    v_perm_b32 v41, v142, v138, s81
    s_waitcnt vmcnt(6)
    s_add_u32 s26, s38, 13
    s_and_b32 s26, s26, 15
    s_lshl_b32 s26, s26, 18
    buffer_load_dwordx4 v[208:211], v3, s[48:51], s26 offen offset:0 nt
    v_perm_b32 v42, v150, v146, s81
    v_perm_b32 v43, v158, v154, s81
    v_mfma_f32_16x16x32_bf16 a[12:15], v[36:39], v[96:99], a[12:15]
    v_perm_b32 v44, v134, v130, s82
    v_perm_b32 v45, v142, v138, s82
    s_waitcnt vmcnt(6)
    buffer_load_dwordx4 v[212:215], v3, s[48:51], s26 offen offset:1024 nt
    v_perm_b32 v46, v150, v146, s82
    v_perm_b32 v47, v158, v154, s82
    v_mfma_f32_16x16x32_bf16 a[16:19], v[40:43], v[96:99], a[16:19]
    v_perm_b32 v48, v135, v131, s81
    v_perm_b32 v49, v143, v139, s81
    s_waitcnt vmcnt(6)
    buffer_load_dwordx4 v[216:219], v3, s[48:51], s26 offen offset:2048 nt
    v_perm_b32 v50, v151, v147, s81
    v_perm_b32 v51, v159, v155, s81
    v_mfma_f32_16x16x32_bf16 a[20:23], v[44:47], v[96:99], a[20:23]
    v_perm_b32 v52, v135, v131, s82
    v_perm_b32 v53, v143, v139, s82
    s_waitcnt vmcnt(6)
    buffer_load_dwordx4 v[220:223], v3, s[48:51], s26 offen offset:3072 nt
    v_perm_b32 v54, v151, v147, s82
    v_perm_b32 v55, v159, v155, s82
    v_mfma_f32_16x16x32_bf16 a[24:27], v[48:51], v[96:99], a[24:27]
    s_nop 0
    v_mfma_f32_16x16x32_bf16 a[28:31], v[52:55], v[96:99], a[28:31]
    s_mov_b32 s88, 0
L_chk_ml:
    v_xor_b32 v13, v69, v5
    v_bitop3_b32 v13, v13, v71, v5 bitop3:0xf6
    v_bitop3_b32 v13, v13, v77, v5 bitop3:0xf6
    v_bitop3_b32 v13, v13, v79, v5 bitop3:0xf6
    v_cmp_ne_u32 vcc, 0, v13
    s_cbranch_vccz L_ok_ml
    s_add_u32 s88, s88, 1
    s_cmp_gt_u32 s88, 262144
    s_cbranch_scc1 L_ok_ml
    s_mov_b64 exec, vcc
    buffer_load_dwordx4 v[68:71], v4, s[68:71], s86 offen offset:0 sc1
    buffer_load_dwordx4 v[76:79], v4, s[68:71], s86 offen offset:1024 sc1
    s_mov_b64 exec, -1
    s_waitcnt vmcnt(0)
    s_branch L_chk_ml
L_ok_ml:
    v_max_f32 v13, v68, v76
    s_nop 1
    v_max_f32_dpp v13, v13, v13 row_ror:8 row_mask:0xf bank_mask:0xf
    v_mov_b32 v14, v13
    s_nop 1
    v_permlane16_swap_b32 v13, v14
    v_max_f32 v13, v13, v14
    v_mov_b32 v14, v13
    s_nop 1
    v_permlane32_swap_b32 v13, v14
    v_max_f32 v13, v13, v14
    v_sub_f32 v68, v68, v13
    v_sub_f32 v76, v76, v13
    v_mul_f32 v68, s84, v68
    v_mul_f32 v76, s84, v76
    v_exp_f32 v68, v68
    v_exp_f32 v76, v76
    v_mul_f32 v15, v68, v70
    v_fmac_f32 v15, v76, v78
    s_nop 1
    v_add_f32_dpp v15, v15, v15 row_ror:8 row_mask:0xf bank_mask:0xf
    v_mov_b32 v14, v15
    s_nop 1
    v_permlane16_swap_b32 v15, v14
    v_add_f32 v15, v15, v14
    v_mov_b32 v14, v15
    s_nop 1
    v_permlane32_swap_b32 v15, v14
    v_add_f32 v15, v15, v14
    ds_write_b32 v63, v13
    ds_write_b32 v63, v15 offset:128
    v_perm_b32 v24, v164, v160, s81
    s_waitcnt vmcnt(6)
    buffer_load_dwordx2 v[72:73], v2, s[68:71], 0 offen sc1
    v_perm_b32 v25, v172, v168, s81
    v_perm_b32 v26, v180, v176, s81
    v_perm_b32 v27, v188, v184, s81
    v_perm_b32 v28, v164, v160, s82
    v_perm_b32 v29, v172, v168, s82
    s_waitcnt vmcnt(6)
    s_add_u32 s26, s38, 14
    s_and_b32 s26, s26, 15
    s_lshl_b32 s26, s26, 18
    buffer_load_dwordx4 v[224:227], v3, s[48:51], s26 offen offset:0 nt
    v_perm_b32 v30, v180, v176, s82
    v_perm_b32 v31, v188, v184, s82
    v_mfma_f32_16x16x32_bf16 a[0:3], v[24:27], v[104:107], a[0:3]
    v_perm_b32 v32, v165, v161, s81
    v_perm_b32 v33, v173, v169, s81
    s_waitcnt vmcnt(6)
    buffer_load_dwordx4 v[228:231], v3, s[48:51], s26 offen offset:1024 nt
    v_perm_b32 v34, v181, v177, s81
    v_perm_b32 v35, v189, v185, s81
    v_mfma_f32_16x16x32_bf16 a[4:7], v[28:31], v[104:107], a[4:7]
    v_perm_b32 v36, v165, v161, s82
    v_perm_b32 v37, v173, v169, s82
    s_waitcnt vmcnt(6)
    buffer_load_dwordx4 v[232:235], v3, s[48:51], s26 offen offset:2048 nt
    v_perm_b32 v38, v181, v177, s82
    v_perm_b32 v39, v189, v185, s82
    v_mfma_f32_16x16x32_bf16 a[8:11], v[32:35], v[104:107], a[8:11]
    v_perm_b32 v40, v166, v162, s81
    v_perm_b32 v41, v174, v170, s81
    s_waitcnt vmcnt(6)
    buffer_load_dwordx4 v[236:239], v3, s[48:51], s26 offen offset:3072 nt
    v_perm_b32 v42, v182, v178, s81
    v_perm_b32 v43, v190, v186, s81
    v_mfma_f32_16x16x32_bf16 a[12:15], v[36:39], v[104:107], a[12:15]
    v_perm_b32 v44, v166, v162, s82
    v_perm_b32 v45, v174, v170, s82
    s_waitcnt vmcnt(6)
    s_add_u32 s26, s38, 15
    s_and_b32 s26, s26, 15
    s_lshl_b32 s26, s26, 18
    buffer_load_dwordx4 v[240:243], v3, s[48:51], s26 offen offset:0 nt
    v_perm_b32 v46, v182, v178, s82
    v_perm_b32 v47, v190, v186, s82
    v_mfma_f32_16x16x32_bf16 a[16:19], v[40:43], v[104:107], a[16:19]
    v_perm_b32 v48, v167, v163, s81
    v_perm_b32 v49, v175, v171, s81
    s_waitcnt vmcnt(6)
    buffer_load_dwordx4 v[244:247], v3, s[48:51], s26 offen offset:1024 nt
    v_perm_b32 v50, v183, v179, s81
    v_perm_b32 v51, v191, v187, s81
    v_mfma_f32_16x16x32_bf16 a[20:23], v[44:47], v[104:107], a[20:23]
    v_perm_b32 v52, v167, v163, s82
    v_perm_b32 v53, v175, v171, s82
    s_waitcnt vmcnt(6)
    buffer_load_dwordx4 v[248:251], v3, s[48:51], s26 offen offset:2048 nt
    v_perm_b32 v54, v183, v179, s82
    v_perm_b32 v55, v191, v187, s82
    v_mfma_f32_16x16x32_bf16 a[24:27], v[48:51], v[104:107], a[24:27]
    s_nop 0
    v_mfma_f32_16x16x32_bf16 a[28:31], v[52:55], v[104:107], a[28:31]
    s_waitcnt vmcnt(6)
    buffer_load_dwordx4 v[252:255], v3, s[48:51], s26 offen offset:3072 nt
    s_waitcnt lgkmcnt(0)
    s_barrier
    ds_read_b128 v[84:87], v12
    ds_read_b128 v[92:95], v12 offset:128
    s_waitcnt lgkmcnt(0)
    v_max3_f32 v13, v84, v85, v86
    v_max_f32 v13, v13, v87
    v_sub_f32 v84, v84, v13
    v_sub_f32 v85, v85, v13
    v_sub_f32 v86, v86, v13
    v_sub_f32 v87, v87, v13
    v_sub_f32 v11, v11, v13
    v_mul_f32 v84, s84, v84
    v_mul_f32 v85, s84, v85
    v_mul_f32 v86, s84, v86
    v_mul_f32 v87, s84, v87
    v_mul_f32 v11, s84, v11
    v_exp_f32 v84, v84
    v_exp_f32 v85, v85
    v_exp_f32 v86, v86
    v_exp_f32 v87, v87
    v_exp_f32 v11, v11
    v_mul_f32 v15, v84, v92
    v_fmac_f32 v15, v85, v93
    v_fmac_f32 v15, v86, v94
    v_fmac_f32 v15, v87, v95
    v_rcp_f32 v14, v15
    s_nop 0
    v_fma_f32 v13, -v15, v14, 1.0
    v_fma_f32 v14, v13, v14, v14
    v_mul_f32 v11, v11, v14
    s_mov_b64 exec, 0xff
    ds_write_b32 v63, v11 offset:2048
    s_mov_b64 exec, -1
    v_perm_b32 v24, v196, v192, s81
    s_cmp_lg_u32 s3, 0
    s_cbranch_scc1 L_w0_xb2
    global_load_short_d16_hi v16, v19, s[16:17]
    global_load_short_d16_hi v18, v18, s[34:35]
L_w0_xb2:
    v_perm_b32 v25, v204, v200, s81
    v_perm_b32 v26, v212, v208, s81
    v_perm_b32 v27, v220, v216, s81
    v_perm_b32 v28, v196, v192, s82
    v_perm_b32 v29, v204, v200, s82
    s_lshl_b32 s27, s79, 2
    s_add_u32 s27, s27, s3
    s_mul_i32 s27, s27, 57344
    s_add_u32 s27, s27, s87
    s_add_u32 m0, s89, 98304
    s_add_u32 s23, s27, 0
    buffer_load_dwordx4 v9, s[64:67], s23 offen nt lds
    v_perm_b32 v30, v212, v208, s82
    v_perm_b32 v31, v220, v216, s82
    v_mfma_f32_16x16x32_bf16 a[0:3], v[24:27], v[112:115], a[0:3]
    v_perm_b32 v32, v197, v193, s81
    v_perm_b32 v33, v205, v201, s81
    s_add_u32 m0, s89, 99328
    s_add_u32 s23, s27, 8192
    buffer_load_dwordx4 v9, s[64:67], s23 offen nt lds
    v_perm_b32 v34, v213, v209, s81
    v_perm_b32 v35, v221, v217, s81
    v_mfma_f32_16x16x32_bf16 a[4:7], v[28:31], v[112:115], a[4:7]
    v_perm_b32 v36, v197, v193, s82
    v_perm_b32 v37, v205, v201, s82
    s_add_u32 m0, s89, 100352
    s_add_u32 s23, s27, 16384
    buffer_load_dwordx4 v8, s[64:67], s23 offen nt lds
    v_perm_b32 v38, v213, v209, s82
    v_perm_b32 v39, v221, v217, s82
    v_mfma_f32_16x16x32_bf16 a[8:11], v[32:35], v[112:115], a[8:11]
    v_perm_b32 v40, v198, v194, s81
    v_perm_b32 v41, v206, v202, s81
    s_add_u32 m0, s89, 101376
    s_add_u32 s23, s27, 24576
    buffer_load_dwordx4 v8, s[64:67], s23 offen nt lds
    v_perm_b32 v42, v214, v210, s81
    v_perm_b32 v43, v222, v218, s81
    v_mfma_f32_16x16x32_bf16 a[12:15], v[36:39], v[112:115], a[12:15]
    v_perm_b32 v44, v198, v194, s82
    v_perm_b32 v45, v206, v202, s82
    v_perm_b32 v46, v214, v210, s82
    v_perm_b32 v47, v222, v218, s82
    v_mfma_f32_16x16x32_bf16 a[16:19], v[40:43], v[112:115], a[16:19]
    v_perm_b32 v48, v199, v195, s81
    v_perm_b32 v49, v207, v203, s81
    v_perm_b32 v50, v215, v211, s81
    v_perm_b32 v51, v223, v219, s81
    v_mfma_f32_16x16x32_bf16 a[20:23], v[44:47], v[112:115], a[20:23]
    v_perm_b32 v52, v199, v195, s82
    v_perm_b32 v53, v207, v203, s82
    v_perm_b32 v54, v215, v211, s82
    v_perm_b32 v55, v223, v219, s82
    v_mfma_f32_16x16x32_bf16 a[24:27], v[48:51], v[112:115], a[24:27]
    s_nop 0
    v_mfma_f32_16x16x32_bf16 a[28:31], v[52:55], v[112:115], a[28:31]
    v_and_b32 v13, 7, v1
    v_lshlrev_b32 v13, 2, v13
    v_lshrrev_b32 v13, v13, v5
    v_bfe_u32 v116, v13, 0, 1
    v_bfe_u32 v14, v13, 1, 1
    v_lshl_or_b32 v116, v14, 16, v116
    v_bfe_u32 v117, v13, 2, 1
    v_bfe_u32 v14, v13, 3, 1
    v_lshl_or_b32 v117, v14, 16, v117
    v_lshrrev_b32 v118, 1, v4
    s_mov_b32 s0, 0x00010001
    s_movk_i32 s78, 0xff
    s_lshr_b32 s72, s79, 1
    s_lshl_b32 s72, s72, 12
    s_lshl_b32 s73, s87, 8
    s_add_u32 s72, s72, s73
    s_and_b32 s73, s79, 1
    s_lshl_b32 s73, s73, 6
    s_add_u32 s72, s72, s73
    s_add_u32 s77, s72, 4194304
    s_waitcnt vmcnt(4)
    v_perm_b32 v24, v228, v224, s81
    v_perm_b32 v25, v236, v232, s81
    v_perm_b32 v26, v244, v240, s81
    v_perm_b32 v27, v252, v248, s81
    v_perm_b32 v28, v228, v224, s82
    v_perm_b32 v29, v236, v232, s82
    v_perm_b32 v30, v244, v240, s82
    v_perm_b32 v31, v252, v248, s82
    v_mfma_f32_16x16x32_bf16 a[0:3], v[24:27], v[120:123], a[0:3]
    v_perm_b32 v32, v229, v225, s81
    v_perm_b32 v33, v237, v233, s81
    v_perm_b32 v34, v245, v241, s81
    v_perm_b32 v35, v253, v249, s81
    v_mfma_f32_16x16x32_bf16 a[4:7], v[28:31], v[120:123], a[4:7]
    v_perm_b32 v36, v229, v225, s82
    v_perm_b32 v37, v237, v233, s82
    v_perm_b32 v38, v245, v241, s82
    v_perm_b32 v39, v253, v249, s82
    v_mfma_f32_16x16x32_bf16 a[8:11], v[32:35], v[120:123], a[8:11]
    ds_write_b128 v56, a[0:3] offset:0
    v_perm_b32 v40, v230, v226, s81
    v_perm_b32 v41, v238, v234, s81
    v_perm_b32 v42, v246, v242, s81
    v_perm_b32 v43, v254, v250, s81
    v_mfma_f32_16x16x32_bf16 a[12:15], v[36:39], v[120:123], a[12:15]
    ds_write_b128 v56, a[4:7] offset:16
    v_perm_b32 v44, v230, v226, s82
    v_perm_b32 v45, v238, v234, s82
    v_perm_b32 v46, v246, v242, s82
    v_perm_b32 v47, v254, v250, s82
    v_mfma_f32_16x16x32_bf16 a[16:19], v[40:43], v[120:123], a[16:19]
    ds_write_b128 v56, a[8:11] offset:32
    v_perm_b32 v48, v231, v227, s81
    v_perm_b32 v49, v239, v235, s81
    v_perm_b32 v50, v247, v243, s81
    v_perm_b32 v51, v255, v251, s81
    v_mfma_f32_16x16x32_bf16 a[20:23], v[44:47], v[120:123], a[20:23]
    ds_write_b128 v56, a[12:15] offset:48
    v_perm_b32 v52, v231, v227, s82
    v_perm_b32 v53, v239, v235, s82
    v_perm_b32 v54, v247, v243, s82
    v_perm_b32 v55, v255, v251, s82
    v_mfma_f32_16x16x32_bf16 a[24:27], v[48:51], v[120:123], a[24:27]
    ds_write_b128 v56, a[16:19] offset:64
    v_mfma_f32_16x16x32_bf16 a[28:31], v[52:55], v[120:123], a[28:31]
    ds_write_b128 v56, a[20:23] offset:80
    s_nop 4
    ds_write_b128 v56, a[24:27] offset:96
    s_nop 0
    ds_write_b128 v56, a[28:31] offset:112
    s_add_u32 s72, s43, 4096
    s_waitcnt lgkmcnt(0)
    s_barrier
    ds_read_b128 v[40:43], v23
    ds_read_b128 v[24:27], v57 offset:0
    ds_read_b128 v[28:31], v57 offset:4224
    ds_read_b128 v[32:35], v57 offset:8448
    ds_read_b128 v[36:39], v57 offset:12672
    s_waitcnt lgkmcnt(3)
    v_mul_f32 v24, v40, v24
    v_mul_f32 v25, v40, v25
    v_mul_f32 v26, v40, v26
    v_mul_f32 v27, v40, v27
    s_waitcnt lgkmcnt(2)
    v_fmac_f32 v24, v41, v28
    v_fmac_f32 v25, v41, v29
    v_fmac_f32 v26, v41, v30
    v_fmac_f32 v27, v41, v31
    s_waitcnt lgkmcnt(1)
    v_fmac_f32 v24, v42, v32
    v_fmac_f32 v25, v42, v33
    v_fmac_f32 v26, v42, v34
    v_fmac_f32 v27, v42, v35
    s_waitcnt lgkmcnt(0)
    v_fmac_f32 v24, v43, v36
    v_fmac_f32 v25, v43, v37
    v_fmac_f32 v26, v43, v38
    v_fmac_f32 v27, v43, v39
    v_add_u32 v24, 0x10000, v24
    v_add_u32 v25, 0x10000, v25
    v_add_u32 v26, 0x10000, v26
    v_add_u32 v27, 0x10000, v27
    v_perm_b32 v48, v25, v24, s82
    v_perm_b32 v49, v27, v26, s82
    v_bfi_b32 v48, s0, v116, v48
    v_bfi_b32 v49, s0, v117, v49
    buffer_store_dwordx2 v[48:49], v58, s[68:71], s42 offen sc1
    s_add_u32 m0, s89, 102400
    s_add_u32 s23, s27, 32768
    buffer_load_dwordx4 v9, s[64:67], s23 offen nt lds
    s_add_u32 m0, s89, 103424
    s_add_u32 s23, s27, 40960
    buffer_load_dwordx4 v9, s[64:67], s23 offen nt lds
    s_add_u32 m0, s89, 104448
    s_add_u32 s23, s27, 49152
    buffer_load_dwordx4 v8, s[64:67], s23 offen nt lds
    s_lshl_b32 s27, s79, 2
    s_add_u32 s27, s27, s3
    s_mul_i32 s27, s27, 65536
    s_add_u32 s27, s27, s87
    s_add_u32 m0, s89, 65536
    s_add_u32 s23, s27, 0
    buffer_load_dwordx4 v9, s[60:63], s23 offen nt lds
    s_add_u32 m0, s89, 66560
    s_add_u32 s23, s27, 8192
    buffer_load_dwordx4 v9, s[60:63], s23 offen nt lds
    s_add_u32 m0, s89, 67584
    s_add_u32 s23, s27, 16384
    buffer_load_dwordx4 v8, s[60:63], s23 offen nt lds
    s_add_u32 m0, s89, 68608
    s_add_u32 s23, s27, 24576
    buffer_load_dwordx4 v8, s[60:63], s23 offen nt lds
    s_add_u32 m0, s89, 69632
    s_add_u32 s23, s27, 32768
    buffer_load_dwordx4 v9, s[60:63], s23 offen nt lds
    s_add_u32 m0, s89, 70656
    s_add_u32 s23, s27, 40960
    buffer_load_dwordx4 v9, s[60:63], s23 offen nt lds
    s_add_u32 m0, s89, 71680
    s_add_u32 s23, s27, 49152
    buffer_load_dwordx4 v8, s[60:63], s23 offen nt lds
    s_add_u32 m0, s89, 72704
    s_add_u32 s23, s27, 57344
    buffer_load_dwordx4 v8, s[60:63], s23 offen nt lds
    buffer_load_dwordx2 v[128:129], v118, s[68:71], s43 offen offset:0
    buffer_load_dwordx2 v[130:131], v118, s[68:71], s43 offen offset:512
    buffer_load_dwordx2 v[132:133], v118, s[68:71], s43 offen offset:1024
    buffer_load_dwordx2 v[134:135], v118, s[68:71], s43 offen offset:1536
    buffer_load_dwordx2 v[136:137], v118, s[68:71], s43 offen offset:2048
    buffer_load_dwordx2 v[138:139], v118, s[68:71], s43 offen offset:2560
    buffer_load_dwordx2 v[140:141], v118, s[68:71], s43 offen offset:3072
    buffer_load_dwordx2 v[142:143], v118, s[68:71], s43 offen offset:3584
    s_mov_b32 s88, 0
L_chk_fh:
    v_xor_b32 v13, v72, v5
    v_bitop3_b32 v13, v13, v73, v5 bitop3:0xf6
    v_cmp_ne_u32 vcc, 0, v13
    s_nop 0
    s_and_b32 s73, vcc_lo, 0x80808080
    s_cbranch_scc0 L_ok_fh
    s_add_u32 s88, s88, 1
    s_cmp_gt_u32 s88, 262144
    s_cbranch_scc1 L_ok_fh
    buffer_load_dwordx2 v[72:73], v2, s[68:71], 0 offen sc1
    s_waitcnt vmcnt(0)
    s_branch L_chk_fh
L_ok_fh:
    v_and_b32 v13, 7, v1
    v_bfe_u32 v14, v1, 3, 2
    v_cmp_gt_u32 vcc, 7, v13
    v_mad_u32_u24 v15, v14, 7, v13
    v_add_u32 v14, 28, v14
    s_lshl_b32 s73, s3, 6
    s_add_u32 s73, s73, 150848
    v_cndmask_b32 v15, v14, v15, vcc
    v_cndmask_b32 v72, 0, v72, vcc
    v_cndmask_b32 v73, 0, v73, vcc
    v_lshl_add_u32 v15, v15, 1, s73
    ds_write_b16 v15, v72
    ds_write_b16_d16_hi v15, v72 offset:272
    ds_write_b16 v15, v73 offset:544
    ds_write_b16_d16_hi v15, v73 offset:816
    s_waitcnt lgkmcnt(0)
    s_waitcnt vmcnt(16)
    s_barrier
    ds_read_b128 v[64:67], v22 offset:1088
    ds_read_b128 v[68:71], v22 offset:1152
    ds_read_b128 v[72:75], v22 offset:1216
    ds_read_b128 v[76:79], v22 offset:1280
    ds_read_b64_tr_b16 a[96:97], v21 offset:32768
    ds_read_b64_tr_b16 a[98:99], v21 offset:33792
    ds_read_b64_tr_b16 a[112:113], v20 offset:32768
    ds_read_b64_tr_b16 a[114:115], v20 offset:33792
    ds_read_b64_tr_b16 a[100:101], v21 offset:40960
    ds_read_b64_tr_b16 a[102:103], v21 offset:41984
    ds_read_b64_tr_b16 a[116:117], v20 offset:40960
    ds_read_b64_tr_b16 a[118:119], v20 offset:41984
    s_waitcnt lgkmcnt(0)
    ds_read_b64_tr_b16 a[104:105], v21 offset:49152
    ds_read_b64_tr_b16 a[106:107], v21 offset:50176
    ds_read_b64_tr_b16 a[120:121], v20 offset:49152
    ds_read_b64_tr_b16 a[122:123], v20 offset:50176
    ds_read_b64_tr_b16 a[108:109], v21 offset:57344
    ds_read_b64_tr_b16 a[110:111], v21 offset:58368
    ds_read_b64_tr_b16 a[124:125], v20 offset:57344
    ds_read_b64_tr_b16 a[126:127], v20 offset:58368
    s_waitcnt lgkmcnt(0)
    v_mfma_f32_16x16x32_bf16 v[24:27], v[64:67], a[96:99], 0
    v_mfma_f32_16x16x32_bf16 v[28:31], v[64:67], a[112:115], 0
    v_mfma_f32_16x16x32_bf16 v[24:27], v[68:71], a[100:103], v[24:27]
    v_mfma_f32_16x16x32_bf16 v[28:31], v[68:71], a[116:119], v[28:31]
    v_mfma_f32_16x16x32_bf16 v[24:27], v[72:75], a[104:107], v[24:27]
    v_mfma_f32_16x16x32_bf16 v[28:31], v[72:75], a[120:123], v[28:31]
    v_mfma_f32_16x16x32_bf16 v[24:27], v[76:79], a[108:111], v[24:27]
    v_mfma_f32_16x16x32_bf16 v[28:31], v[76:79], a[124:127], v[28:31]
    s_waitcnt vmcnt(8)
    s_barrier
    ds_read_b64_tr_b16 a[64:65], v21 offset:0
    ds_read_b64_tr_b16 a[66:67], v21 offset:1024
    ds_read_b64_tr_b16 a[80:81], v20 offset:0
    ds_read_b64_tr_b16 a[82:83], v20 offset:1024
    ds_read_b64_tr_b16 a[68:69], v21 offset:8192
    ds_read_b64_tr_b16 a[70:71], v21 offset:9216
    ds_read_b64_tr_b16 a[84:85], v20 offset:8192
    ds_read_b64_tr_b16 a[86:87], v20 offset:9216
    ds_read_b64_tr_b16 a[72:73], v21 offset:16384
    ds_read_b64_tr_b16 a[74:75], v21 offset:17408
    ds_read_b64_tr_b16 a[88:89], v20 offset:16384
    ds_read_b64_tr_b16 a[90:91], v20 offset:17408
    v_mov_b32_dpp v24, v28 quad_perm:[0,1,2,3] row_mask:0x8 bank_mask:0xf
    v_mov_b32_dpp v25, v29 quad_perm:[0,1,2,3] row_mask:0x8 bank_mask:0xf
    v_mov_b32_dpp v26, v30 quad_perm:[0,1,2,3] row_mask:0x8 bank_mask:0xf
    v_mov_b32_dpp v27, v31 quad_perm:[0,1,2,3] row_mask:0x8 bank_mask:0xf
    s_mov_b32 s88, 0
    s_waitcnt vmcnt(0)
L_chk_op:
    v_xor_b32 v144, v128, v116
    v_xor_b32 v145, v129, v117
    v_xor_b32 v146, v130, v116
    v_xor_b32 v147, v131, v117
    v_xor_b32 v148, v132, v116
    v_xor_b32 v149, v133, v117
    v_xor_b32 v150, v134, v116
    v_xor_b32 v151, v135, v117
    v_xor_b32 v152, v136, v116
    v_xor_b32 v153, v137, v117
    v_xor_b32 v154, v138, v116
    v_xor_b32 v155, v139, v117
    v_xor_b32 v156, v140, v116
    v_xor_b32 v157, v141, v117
    v_xor_b32 v158, v142, v116
    v_xor_b32 v159, v143, v117
    v_or_b32 v13, v144, v145
    v_or_b32 v14, v146, v147
    v_or3_b32 v13, v13, v148, v149
    v_or3_b32 v14, v14, v150, v151
    v_or3_b32 v13, v13, v152, v153
    v_or3_b32 v14, v14, v154, v155
    v_or3_b32 v13, v13, v156, v157
    v_or3_b32 v14, v14, v158, v159
    v_or_b32 v13, v13, v14
    v_and_b32 v13, 0x00010001, v13
    v_cmp_ne_u32 vcc, 0, v13
    s_cbranch_vccz L_ok_op
    s_add_u32 s88, s88, 1
    s_cmp_gt_u32 s88, 262144
    s_cbranch_scc1 L_ok_op
    v_or_b32_dpp v13, v13, v13 quad_perm:[1,0,3,2] row_mask:0xf bank_mask:0xf
    s_nop 1
    v_or_b32_dpp v13, v13, v13 quad_perm:[2,3,0,1] row_mask:0xf bank_mask:0xf
    s_nop 1
    v_or_b32_dpp v13, v13, v13 row_half_mirror row_mask:0xf bank_mask:0xf
    v_cmp_ne_u32 vcc, 0, v13
    s_nop 0
    s_mov_b64 exec, vcc
    buffer_load_dwordx2 v[128:129], v118, s[68:71], s43 offen offset:0 sc1
    buffer_load_dwordx2 v[130:131], v118, s[68:71], s43 offen offset:512 sc1
    buffer_load_dwordx2 v[132:133], v118, s[68:71], s43 offen offset:1024 sc1
    buffer_load_dwordx2 v[134:135], v118, s[68:71], s43 offen offset:1536 sc1
    buffer_load_dwordx2 v[136:137], v118, s[68:71], s43 offen offset:2048 sc1
    buffer_load_dwordx2 v[138:139], v118, s[68:71], s43 offen offset:2560 sc1
    buffer_load_dwordx2 v[140:141], v118, s[68:71], s43 offen offset:3072 sc1
    buffer_load_dwordx2 v[142:143], v118, s[68:71], s43 offen offset:3584 sc1
    s_mov_b64 exec, -1
    s_waitcnt vmcnt(0)
    s_branch L_chk_op
L_ok_op:
    s_waitcnt lgkmcnt(0)
    ds_read_b64_tr_b16 a[76:77], v21 offset:24576
    ds_read_b64_tr_b16 a[78:79], v21 offset:25600
    ds_read_b64_tr_b16 a[92:93], v20 offset:24576
    ds_read_b64_tr_b16 a[94:95], v20 offset:25600
    v_lshlrev_b32 v224, 16, v144
    v_and_b32 v225, 0xffff0000, v144
    v_lshlrev_b32 v226, 16, v145
    v_and_b32 v227, 0xffff0000, v145
    v_lshlrev_b32 v228, 16, v146
    v_and_b32 v229, 0xffff0000, v146
    v_lshlrev_b32 v230, 16, v147
    v_and_b32 v231, 0xffff0000, v147
    v_lshlrev_b32 v232, 16, v148
    v_and_b32 v233, 0xffff0000, v148
    v_lshlrev_b32 v234, 16, v149
    v_and_b32 v235, 0xffff0000, v149
    v_lshlrev_b32 v236, 16, v150
    v_and_b32 v237, 0xffff0000, v150
    v_lshlrev_b32 v238, 16, v151
    v_and_b32 v239, 0xffff0000, v151
    v_lshlrev_b32 v240, 16, v152
    v_and_b32 v241, 0xffff0000, v152
    v_lshlrev_b32 v242, 16, v153
    v_and_b32 v243, 0xffff0000, v153
    v_lshlrev_b32 v244, 16, v154
    v_and_b32 v245, 0xffff0000, v154
    v_lshlrev_b32 v246, 16, v155
    v_and_b32 v247, 0xffff0000, v155
    v_lshlrev_b32 v248, 16, v156
    v_and_b32 v249, 0xffff0000, v156
    v_lshlrev_b32 v250, 16, v157
    v_and_b32 v251, 0xffff0000, v157
    v_lshlrev_b32 v252, 16, v158
    v_and_b32 v253, 0xffff0000, v158
    v_lshlrev_b32 v254, 16, v159
    v_and_b32 v255, 0xffff0000, v159
    v_pk_add_f32 v[160:161], v[224:225], v[228:229]
    v_pk_add_f32 v[162:163], v[226:227], v[230:231]
    v_pk_add_f32 v[164:165], v[232:233], v[236:237]
    v_pk_add_f32 v[166:167], v[234:235], v[238:239]
    v_pk_add_f32 v[168:169], v[240:241], v[244:245]
    v_pk_add_f32 v[170:171], v[242:243], v[246:247]
    v_pk_add_f32 v[172:173], v[248:249], v[252:253]
    v_pk_add_f32 v[174:175], v[250:251], v[254:255]
    v_pk_add_f32 v[160:161], v[160:161], v[164:165]
    v_pk_add_f32 v[162:163], v[162:163], v[166:167]
    v_pk_add_f32 v[168:169], v[168:169], v[172:173]
    v_pk_add_f32 v[170:171], v[170:171], v[174:175]
    v_pk_add_f32 v[160:161], v[160:161], v[168:169]
    v_pk_add_f32 v[162:163], v[162:163], v[170:171]
    v_mov_b32 v164, v160
    v_mov_b32 v165, v161
    v_mov_b32 v166, v162
    v_mov_b32 v167, v163
    v_permlane32_swap_b32 v160, v164
    v_permlane32_swap_b32 v161, v165
    v_permlane32_swap_b32 v162, v166
    v_permlane32_swap_b32 v163, v167
    v_add_f32 v160, v160, v164
    v_add_f32 v161, v161, v165
    v_add_f32 v162, v162, v166
    v_add_f32 v163, v163, v167
    v_cvt_pk_bf16_f32 v160, v160, v161
    v_cvt_pk_bf16_f32 v162, v162, v163
    s_mov_b32 exec_hi, 0
    ds_write_b16 v59, v160
    ds_write_b16_d16_hi v59, v160 offset:16
    ds_write_b16 v59, v162 offset:32
    ds_write_b16_d16_hi v59, v162 offset:48
    s_mov_b64 exec, -1
    s_waitcnt lgkmcnt(0)
    s_barrier
    ds_read_b128 v[80:83], v22 offset:0
    ds_read_b128 v[84:87], v22 offset:64
    ds_read_b128 v[88:91], v22 offset:128
    ds_read_b128 v[92:95], v22 offset:192
    s_waitcnt lgkmcnt(3)
    v_mfma_f32_16x16x32_bf16 v[32:35], v[80:83], a[64:67], 0
    v_mfma_f32_16x16x32_bf16 v[36:39], v[80:83], a[80:83], 0
    s_waitcnt lgkmcnt(2)
    v_mfma_f32_16x16x32_bf16 v[32:35], v[84:87], a[68:71], v[32:35]
    v_mfma_f32_16x16x32_bf16 v[36:39], v[84:87], a[84:87], v[36:39]
    s_waitcnt lgkmcnt(1)
    v_mfma_f32_16x16x32_bf16 v[32:35], v[88:91], a[72:75], v[32:35]
    v_mfma_f32_16x16x32_bf16 v[36:39], v[88:91], a[88:91], v[36:39]
    s_waitcnt lgkmcnt(0)
    v_mfma_f32_16x16x32_bf16 v[32:35], v[92:95], a[76:79], v[32:35]
    v_mfma_f32_16x16x32_bf16 v[36:39], v[92:95], a[92:95], v[36:39]
    s_cmp_eq_u32 s80, 0
    s_nop 5
    v_mov_b32_dpp v24, v32 quad_perm:[0,1,2,3] row_mask:1 bank_mask:0xf
    v_mov_b32_dpp v25, v33 quad_perm:[0,1,2,3] row_mask:1 bank_mask:0xf
    v_mov_b32_dpp v26, v34 quad_perm:[0,1,2,3] row_mask:1 bank_mask:0xf
    v_mov_b32_dpp v27, v35 quad_perm:[0,1,2,3] row_mask:1 bank_mask:0xf
    v_mov_b32_dpp v24, v36 quad_perm:[0,1,2,3] row_mask:2 bank_mask:0xf
    v_mov_b32_dpp v25, v37 quad_perm:[0,1,2,3] row_mask:2 bank_mask:0xf
    v_mov_b32_dpp v26, v38 quad_perm:[0,1,2,3] row_mask:2 bank_mask:0xf
    v_mov_b32_dpp v27, v39 quad_perm:[0,1,2,3] row_mask:2 bank_mask:0xf
    v_bfi_b32 v48, s78, v100, v24
    v_bfi_b32 v49, s78, v101, v25
    v_bfi_b32 v50, s78, v102, v26
    v_bfi_b32 v51, s78, v103, v27
    s_cbranch_scc1 L_zplain
    buffer_store_dwordx4 v[48:51], v7, s[68:71], s85 offen sc1
    s_branch L_zdone
L_zplain:
    buffer_store_dwordx4 v[48:51], v7, s[68:71], s85 offen
L_zdone:
    s_cmp_lg_u32 s3, 0
    s_cbranch_scc1 L_end
    buffer_load_dwordx4 v[192:195], v17, s[68:71], s77 offen offset:0 sc1
    buffer_load_dwordx4 v[196:199], v17, s[68:71], s77 offen offset:1024 sc1
    buffer_load_dwordx4 v[200:203], v17, s[68:71], s77 offen offset:2048 sc1
    buffer_load_dwordx4 v[204:207], v17, s[68:71], s77 offen offset:3072 sc1
    v_and_b32 v160, 0xffff0000, v16
    s_mov_b32 exec_lo, 0
    v_and_b32 v160, 0xffff0000, v18
    s_mov_b64 exec, -1
    s_mov_b32 s88, 0
    s_waitcnt vmcnt(0)
L_chk_z:
    v_xor_b32 v208, v192, v100
    v_xor_b32 v209, v193, v101
    v_xor_b32 v210, v194, v102
    v_xor_b32 v211, v195, v103
    v_xor_b32 v212, v196, v100
    v_xor_b32 v213, v197, v101
    v_xor_b32 v214, v198, v102
    v_xor_b32 v215, v199, v103
    v_xor_b32 v216, v200, v100
    v_xor_b32 v217, v201, v101
    v_xor_b32 v218, v202, v102
    v_xor_b32 v219, v203, v103
    v_xor_b32 v220, v204, v100
    v_xor_b32 v221, v205, v101
    v_xor_b32 v222, v206, v102
    v_xor_b32 v223, v207, v103
    v_or_b32 v13, v208, v209
    v_or_b32 v14, v210, v211
    v_or3_b32 v13, v13, v212, v213
    v_or3_b32 v14, v14, v214, v215
    v_or3_b32 v13, v13, v216, v217
    v_or3_b32 v14, v14, v218, v219
    v_or3_b32 v13, v13, v220, v221
    v_or3_b32 v14, v14, v222, v223
    v_or_b32 v13, v13, v14
    v_and_b32 v13, 0xff, v13
    v_cmp_ne_u32 vcc, 0, v13
    s_cbranch_vccz L_ok_z
    s_add_u32 s88, s88, 1
    s_cmp_gt_u32 s88, 262144
    s_cbranch_scc1 L_ok_z
    buffer_load_dwordx4 v[192:195], v17, s[68:71], s77 offen offset:0 sc1
    buffer_load_dwordx4 v[196:199], v17, s[68:71], s77 offen offset:1024 sc1
    buffer_load_dwordx4 v[200:203], v17, s[68:71], s77 offen offset:2048 sc1
    buffer_load_dwordx4 v[204:207], v17, s[68:71], s77 offen offset:3072 sc1
    s_waitcnt vmcnt(0)
    s_branch L_chk_z
L_ok_z:
    v_pk_add_f32 v[208:209], v[208:209], v[212:213]
    v_pk_add_f32 v[210:211], v[210:211], v[214:215]
    v_pk_add_f32 v[216:217], v[216:217], v[220:221]
    v_pk_add_f32 v[218:219], v[218:219], v[222:223]
    v_pk_add_f32 v[208:209], v[208:209], v[216:217]
    v_pk_add_f32 v[210:211], v[210:211], v[218:219]
    s_nop 0
    v_add_f32_dpp v208, v208, v208 row_ror:4 row_mask:0xf bank_mask:0xf
    v_add_f32_dpp v209, v209, v209 row_ror:4 row_mask:0xf bank_mask:0xf
    v_add_f32_dpp v210, v210, v210 row_ror:4 row_mask:0xf bank_mask:0xf
    v_add_f32_dpp v211, v211, v211 row_ror:4 row_mask:0xf bank_mask:0xf
    v_add_f32_dpp v208, v208, v208 row_ror:8 row_mask:0xf bank_mask:0xf
    v_add_f32_dpp v209, v209, v209 row_ror:8 row_mask:0xf bank_mask:0xf
    v_add_f32_dpp v210, v210, v210 row_ror:8 row_mask:0xf bank_mask:0xf
    v_add_f32_dpp v211, v211, v211 row_ror:8 row_mask:0xf bank_mask:0xf
    v_mov_b32_dpp v208, v209 quad_perm:[0,1,2,3] row_mask:0xf bank_mask:0x2
    s_nop 1
    v_mov_b32_dpp v208, v210 quad_perm:[0,1,2,3] row_mask:0xf bank_mask:0x4
    s_nop 1
    v_mov_b32_dpp v208, v211 quad_perm:[0,1,2,3] row_mask:0xf bank_mask:0x8
    v_mov_b32 v161, v208
    s_nop 1
    v_permlane16_swap_b32 v208, v161
    v_add_f32 v208, v208, v161
    v_cvt_pk_bf16_f32 v208, v208, v208
    v_lshlrev_b32 v208, 16, v208
    v_add_f32 v160, v160, v208
    v_cvt_pk_bf16_f32 v160, v160, v160
    v_lshlrev_b32 v160, 16, v160
    v_mov_b32 v161, v160
    s_nop 1
    v_permlane32_swap_b32 v160, v161
    v_add_f32 v160, v160, v161
    v_cvt_pk_bf16_f32 v160, v160, v160
    s_mov_b64 exec, 0xffff
    global_store_short v19, v160, s[36:37]
    s_cmp_lg_u32 s2, 0
    s_cbranch_scc1 L_end
    s_mov_b64 exec, 1
    v_mov_b32 v13, 0
    global_store_dword v13, v5, s[40:41] sc1
L_end:
    s_endpgm
.section .rodata,"a"
.p2align 6
.amdhsa_kernel parallel_sum__gqa_block_cached__mixer_channel_mlp__decode_kernel
  .amdhsa_next_free_vgpr 512
  .amdhsa_next_free_sgpr 102
  .amdhsa_accum_offset 256
  .amdhsa_group_segment_fixed_size 0
  .amdhsa_kernarg_size 104
  .amdhsa_user_sgpr_count 2
  .amdhsa_user_sgpr_kernarg_segment_ptr 1
  .amdhsa_system_sgpr_workgroup_id_x 1
  .amdhsa_float_denorm_mode_32 3
.end_amdhsa_kernel
```
